```python
import torch

def _softmax(x, axis=-1):
    return torch.softmax(x, dim=axis)
def _gelu(x):
    return torch.nn.functional.gelu(x, approximate="tanh")
def _silu(x):
    return torch.nn.functional.silu(x)
def _sigmoid(x):
    return torch.sigmoid(x)
def _layernorm(x, axis=-1, eps=1e-5):
    m = x.mean(dim=axis, keepdim=True)
    v = x.var(dim=axis, keepdim=True, unbiased=False)
    return (x - m) / torch.sqrt(v + eps)
def _scatter_add(tgt, idx, src, axis=0):
    return tgt.clone().index_add_(axis, idx, src)
def _segment_sum(src, seg, n):
    out = torch.zeros((n,) + src.shape[1:], dtype=src.dtype)
    return out.index_add_(0, seg, src)
def _pad(x, pw):
    flat = tuple(v for pair in reversed(pw) for v in pair)
    return torch.nn.functional.pad(x, flat)

kernel_name = 'gated_mix__mha_block__spectral_fnet__prompt'

def setup_inputs():

    _w = (lambda a: (lambda t: t.to(torch.bfloat16) if t.is_floating_point() else t)(torch.as_tensor(a)))
    def _A_setup():
        B, S, D, H = 1, 2048, 640, 32
        return {
            "x": _w((lambda *s: torch.randn(*s, dtype=torch.bfloat16) * 0.05)(B, S, D)),
            "wqkv": _w((lambda *s: torch.randn(*s, dtype=torch.bfloat16) * 1.6)(D, 3 * D)),
            "wo": _w((lambda *s: torch.randn(*s, dtype=torch.bfloat16) * 1.6)(D, D)),
        }
    _A_in = _A_setup()

    def _B_setup():
        B, S, D = 1, 2048, 640
        ns = torch.arange(S)[:, None] * torch.arange(S)[None, :]
        nd = torch.arange(D)[:, None] * torch.arange(D)[None, :]
        Ws_re = torch.cos(-2.0 * torch.pi * ns / S).to(float)
        Ws_im = torch.sin(-2.0 * torch.pi * ns / S).to(float)
        Wd_re = torch.cos(-2.0 * torch.pi * nd / D).to(float)
        Wd_im = torch.sin(-2.0 * torch.pi * nd / D).to(float)
        return {
            "x": _w((lambda *s: torch.randn(*s, dtype=torch.bfloat16) * 0.05)(B, S, D)),
            "dft_seq_re": _w(Ws_re),
            "dft_seq_im": _w(Ws_im),
            "dft_hid_re": _w(Wd_re),
            "dft_hid_im": _w(Wd_im),
        }
    _B_in = _B_setup()

    return {
        "A_x": _A_in["x"],
        "A_wqkv": _A_in["wqkv"],
        "A_wo": _A_in["wo"],
        "B_x": _B_in["x"],
        "B_dft_seq_re": _B_in["dft_seq_re"],
        "B_dft_seq_im": _B_in["dft_seq_im"],
        "B_dft_hid_re": _B_in["dft_hid_re"],
        "B_dft_hid_im": _B_in["dft_hid_im"],
        "gate_w": _w((lambda *s: torch.randn(*s, dtype=torch.bfloat16) * 0.05)(640) * 16.0),
    }

def reference(A_x, A_wqkv, A_wo, B_x, B_dft_seq_re, B_dft_seq_im, B_dft_hid_re, B_dft_hid_im, gate_w):
    def _A_ref(x, wqkv, wo):
        B, S, D = x.shape
        H = 32
        Dh = D // H
        qkv = (lambda x, *d: x.permute(*d))((x @ wqkv).reshape(B, S, 3, H, Dh), 2, 0, 3, 1, 4)
        q, k, v = qkv[0], qkv[1], qkv[2]
        scores = torch.einsum("bhqd,bhkd->bhqk", q, k) * (Dh ** -0.5)
        p = _softmax(scores, axis=-1)
        o = torch.einsum("bhqk,bhkd->bhqd", p, v)
        return (lambda x, *d: x.permute(*d))(o, 0, 2, 1, 3).reshape(B, S, D) @ wo

    def _B_ref(x, dft_seq_re, dft_seq_im, dft_hid_re, dft_hid_im):
        a = torch.einsum("bsd,ed->bse", x, dft_hid_re)
        b = torch.einsum("bsd,ed->bse", x, dft_hid_im)
        y = torch.einsum("ts,bse->bte", dft_seq_re, a) - torch.einsum("ts,bse->bte", dft_seq_im, b)
        return y

    x = A_x
    g = _sigmoid((x * gate_w).sum(-1, keepdims=True))
    a = _A_ref(x, A_wqkv, A_wo)
    b = _B_ref(x, B_dft_seq_re, B_dft_seq_im, B_dft_hid_re, B_dft_hid_im)
    return g * a + (1 - g) * b
```

```asm
; @launch kernel=qkv_dft1_kernel grid=(256,1,1) block=(512,1,1) lds=159744
; @launch kernel=attn_dft2_kernel grid=(256,1,1) block=(768,1,1) lds=163840
; @launch kernel=outproj_mix_kernel grid=(256,1,1) block=(512,1,1) lds=102400
.amdgcn_target "amdgcn-amd-amdhsa--gfx950"
.text
.globl qkv_dft1_kernel
.p2align 8
.type qkv_dft1_kernel,@function
qkv_dft1_kernel:
    s_cmp_ge_u32 s2, 256
    s_cbranch_scc1 L_k1_exit
    s_load_dwordx4 s[24:27], s[0:1], 0
    s_load_dwordx4 s[28:31], s[0:1], 48
    s_load_dwordx2 s[32:33], s[0:1], 88
    s_load_dwordx4 s[4:7], s[0:1], 32
    v_and_b32 v1, 63, v0
    v_lshrrev_b32 v2, 6, v0
    s_nop 0
    v_readfirstlane_b32 s36, v2
    s_and_b32 s44, s2, 1
    s_lshl_b32 s44, s44, 3
    s_bfe_u32 s45, s2, 0x30003
    s_add_u32 s37, s44, s45
    s_bfe_u32 s44, s2, 0x20001
    s_lshl_b32 s44, s44, 2
    s_lshr_b32 s45, s2, 6
    s_add_u32 s38, s44, s45
    s_bfe_u32 s39, s36, 0x10001
    s_and_b32 s40, s36, 1
    s_and_b32 s44, s38, 1
    s_cmp_lt_u32 s38, 12
    s_cselect_b32 s44, s38, s44
    s_cselect_b32 s41, 3840, 64
    s_mul_i32 s42, s44, 320
    s_cselect_b32 s45, 0, 1216
    s_add_u32 s41, s41, s45
    s_lshl_b32 s63, s41, 6
    s_mul_i32 s46, s41, 640
    s_waitcnt lgkmcnt(0)
    s_mov_b32 s8, s24
    s_mov_b32 s9, s25
    s_mov_b32 s10, 2621440
    s_mov_b32 s11, 0x00020000
    s_cmp_lt_u32 s38, 14
    s_cselect_b32 s12, s28, s30
    s_cselect_b32 s13, s29, s31
    s_cmp_lt_u32 s38, 12
    s_cselect_b32 s12, s26, s12
    s_cselect_b32 s13, s27, s13
    s_mov_b32 s14, s46
    s_mov_b32 s15, 0x00020000
    s_mov_b32 s20, s32
    s_mov_b32 s21, s33
    s_mov_b32 s22, 20971520
    s_mov_b32 s23, 0x00020000
    s_cmp_lt_u32 s2, 128
    s_cselect_b32 s16, s4, s6
    s_cselect_b32 s17, s5, s7
    s_mov_b32 s18, 8388608
    s_mov_b32 s19, 0x00020000
    s_cmp_ge_u32 s36, 4
    s_cbranch_scc1 L_k1_loader
    v_mul_u32_u24 v8, 86, v1
    v_lshrrev_b32 v8, 8, v8
    v_mul_u32_u24 v9, 3, v8
    v_sub_u32 v9, v1, v9
    s_and_b32 s44, s37, 7
    s_mul_i32 s44, s44, 80
    s_mul_i32 s45, s36, 20
    s_add_u32 s44, s44, s45
    v_min_u32 v8, 19, v8
    v_add_u32 v8, s44, v8
    v_mul_lo_u32 v8, v8, s41
    v_lshl_add_u32 v8, v9, 7, v8
    buffer_load_dword v168, v8, s[12:15], s42 offen
    s_and_b32 s44, s38, 3
    s_lshl_b32 s44, s44, 4
    s_lshl_b32 s45, s36, 2
    s_add_u32 s44, s44, s45
    s_lshl_b32 s45, s37, 6
    s_add_u32 s44, s44, s45
    v_bfe_u32 v8, v1, 3, 2
    v_add_u32 v8, s44, v8
    v_sub_u32 v9, 2047, v8
    v_cmp_gt_u32 vcc, 32, v1
    v_and_b32 v11, 7, v1
    s_nop 0
    v_cndmask_b32 v8, v9, v8, vcc
    v_mul_u32_u24 v8, 1280, v8
    v_lshl_add_u32 v8, v11, 7, v8
    v_and_b32 v8, 15, v1
    v_lshrrev_b32 v9, 4, v1
    v_lshrrev_b32 v10, 1, v8
    v_xor_b32 v11, v9, v10
    s_lshl_b32 s44, s39, 12
    v_lshlrev_b32 v12, 7, v8
    v_add_u32 v12, s44, v12
    v_lshl_add_u32 v2, v11, 4, v12
    v_xor_b32 v3, 64, v2
    v_lshrrev_b32 v10, 2, v8
    v_and_b32 v11, 3, v8
    v_lshl_add_u32 v12, v9, 3, v10
    v_mul_u32_u24 v12, 320, v12
    v_lshl_add_u32 v12, v11, 3, v12
    s_mul_i32 s44, s40, 160
    s_add_u32 s44, s44, 16384
    v_add_u32 v12, s44, v12
    v_and_b32 v13, 1, v9
    v_lshlrev_b32 v13, 5, v13
    v_add_u32 v14, v12, v13
    v_sub_u32 v15, v12, v13
    s_cmp_eq_u32 s40, 0
    s_cselect_b64 vcc, -1, 0
    v_cndmask_b32 v4, v15, v14, vcc
    v_cndmask_b32 v5, v14, v15, vcc
    v_mov_b32 v88, 0
    v_mov_b32 v89, 0
    v_mov_b32 v90, 0
    v_mov_b32 v91, 0
    v_mov_b32 v92, 0
    v_mov_b32 v93, 0
    v_mov_b32 v94, 0
    v_mov_b32 v95, 0
    v_mov_b32 v96, 0
    v_mov_b32 v97, 0
    v_mov_b32 v98, 0
    v_mov_b32 v99, 0
    v_mov_b32 v100, 0
    v_mov_b32 v101, 0
    v_mov_b32 v102, 0
    v_mov_b32 v103, 0
    v_mov_b32 v104, 0
    v_mov_b32 v105, 0
    v_mov_b32 v106, 0
    v_mov_b32 v107, 0
    v_mov_b32 v108, 0
    v_mov_b32 v109, 0
    v_mov_b32 v110, 0
    v_mov_b32 v111, 0
    v_mov_b32 v112, 0
    v_mov_b32 v113, 0
    v_mov_b32 v114, 0
    v_mov_b32 v115, 0
    v_mov_b32 v116, 0
    v_mov_b32 v117, 0
    v_mov_b32 v118, 0
    v_mov_b32 v119, 0
    v_mov_b32 v120, 0
    v_mov_b32 v121, 0
    v_mov_b32 v122, 0
    v_mov_b32 v123, 0
    v_mov_b32 v124, 0
    v_mov_b32 v125, 0
    v_mov_b32 v126, 0
    v_mov_b32 v127, 0
    v_mov_b32 v128, 0
    v_mov_b32 v129, 0
    v_mov_b32 v130, 0
    v_mov_b32 v131, 0
    v_mov_b32 v132, 0
    v_mov_b32 v133, 0
    v_mov_b32 v134, 0
    v_mov_b32 v135, 0
    v_mov_b32 v136, 0
    v_mov_b32 v137, 0
    v_mov_b32 v138, 0
    v_mov_b32 v139, 0
    v_mov_b32 v140, 0
    v_mov_b32 v141, 0
    v_mov_b32 v142, 0
    v_mov_b32 v143, 0
    v_mov_b32 v144, 0
    v_mov_b32 v145, 0
    v_mov_b32 v146, 0
    v_mov_b32 v147, 0
    v_mov_b32 v148, 0
    v_mov_b32 v149, 0
    v_mov_b32 v150, 0
    v_mov_b32 v151, 0
    v_mov_b32 v152, 0
    v_mov_b32 v153, 0
    v_mov_b32 v154, 0
    v_mov_b32 v155, 0
    v_mov_b32 v156, 0
    v_mov_b32 v157, 0
    v_mov_b32 v158, 0
    v_mov_b32 v159, 0
    v_mov_b32 v160, 0
    v_mov_b32 v161, 0
    v_mov_b32 v162, 0
    v_mov_b32 v163, 0
    v_mov_b32 v164, 0
    v_mov_b32 v165, 0
    v_mov_b32 v166, 0
    v_mov_b32 v167, 0
    v_mov_b32 v60, 0
    v_mov_b32 v61, 0
    v_mov_b32 v62, 0
    v_mov_b32 v63, 0
    v_mov_b32 v64, 0
    v_mov_b32 v65, 0
    v_mov_b32 v66, 0
    v_mov_b32 v67, 0
    v_mov_b32 v68, 0
    v_mov_b32 v69, 0
    v_mov_b32 v70, 0
    v_mov_b32 v71, 0
    s_mov_b32 s65, 0
    s_mov_b32 s66, 0
    s_cmp_ge_u32 s38, 12
    s_cbranch_scc1 L_cpd_1
    s_and_b32 s44, s38, 3
    s_lshl_b32 s44, s44, 3
    s_add_u32 s44, s44, s36
    s_mul_i32 s44, s44, 81920
    s_mul_i32 s45, s37, 5120
    s_add_u32 s67, s44, s45
    s_mov_b32 s68, 5
    s_cmp_lt_u32 s38, 4
    s_cbranch_scc1 L_cpe_2
    s_lshl_b32 s67, s67, 1
    s_add_u32 s67, s67, 2621440
    s_cmp_lt_u32 s38, 8
    s_cbranch_scc1 L_cpe_2
    s_add_u32 s67, s67, 5120
    s_branch L_cpe_2
L_cpd_1:
    s_cmp_lt_u32 s38, 14
    s_mov_b32 s47, 8650752
    s_cselect_b32 s47, 7864320, s47
    s_and_b32 s44, s38, 1
    s_mul_i32 s44, s44, 5
    s_add_u32 s44, s44, s36
    s_mul_i32 s44, s44, 67584
    s_lshl_b32 s45, s37, 12
    s_add_u32 s67, s44, s45
    s_add_u32 s67, s67, s47
    s_cmp_lt_u32 s36, 5
    s_cselect_b32 s68, 4, 0
L_cpe_2:
    s_cmp_ge_u32 s38, 8
    s_cbranch_scc1 L_k1_c1
    v_and_b32 v8, 15, v1
    v_lshrrev_b32 v9, 4, v1
    s_lshl_b32 s46, s39, 10
    s_lshl_b32 s47, s39, 3
    s_add_u32 s47, s47, 4096
    s_mul_i32 s50, s40, 20
    v_lshlrev_b32 v18, 4, v8
    v_add_u32 v18, 73728, v18
    v_add_u32 v9, s50, v9
    v_mov_b32 v15, s47
    v_mov_b32 v17, 512
    v_mul_u32_u24 v11, 205, v9
    v_lshrrev_b32 v11, 10, v11
    v_mul_u32_u24 v12, 5, v11
    v_sub_u32 v14, v9, v12
    v_mul_u32_u24 v11, 5120, v11
    v_add_u32 v11, v11, v18
    v_lshrrev_b32 v12, 1, v14
    v_lshlrev_b32 v12, 9, v12
    v_and_b32 v13, 1, v14
    v_lshl_add_u32 v12, v13, 3, v12
    v_cmp_eq_u32 vcc, 4, v14
    v_add_u32 v12, s46, v12
    v_mov_b32 v16, 2048
    v_cndmask_b32 v12, v12, v15, vcc
    v_cndmask_b32 v16, v16, v17, vcc
    v_add_u32 v60, v11, v12
    v_add_u32 v61, v60, v16
    v_add_u32 v9, 4, v9
    v_mul_u32_u24 v11, 205, v9
    v_lshrrev_b32 v11, 10, v11
    v_mul_u32_u24 v12, 5, v11
    v_sub_u32 v14, v9, v12
    v_mul_u32_u24 v11, 5120, v11
    v_add_u32 v11, v11, v18
    v_lshrrev_b32 v12, 1, v14
    v_lshlrev_b32 v12, 9, v12
    v_and_b32 v13, 1, v14
    v_lshl_add_u32 v12, v13, 3, v12
    v_cmp_eq_u32 vcc, 4, v14
    v_add_u32 v12, s46, v12
    v_mov_b32 v16, 2048
    v_cndmask_b32 v12, v12, v15, vcc
    v_cndmask_b32 v16, v16, v17, vcc
    v_add_u32 v62, v11, v12
    v_add_u32 v63, v62, v16
    v_add_u32 v9, 4, v9
    v_mul_u32_u24 v11, 205, v9
    v_lshrrev_b32 v11, 10, v11
    v_mul_u32_u24 v12, 5, v11
    v_sub_u32 v14, v9, v12
    v_mul_u32_u24 v11, 5120, v11
    v_add_u32 v11, v11, v18
    v_lshrrev_b32 v12, 1, v14
    v_lshlrev_b32 v12, 9, v12
    v_and_b32 v13, 1, v14
    v_lshl_add_u32 v12, v13, 3, v12
    v_cmp_eq_u32 vcc, 4, v14
    v_add_u32 v12, s46, v12
    v_mov_b32 v16, 2048
    v_cndmask_b32 v12, v12, v15, vcc
    v_cndmask_b32 v16, v16, v17, vcc
    v_add_u32 v64, v11, v12
    v_add_u32 v65, v64, v16
    v_add_u32 v9, 4, v9
    v_mul_u32_u24 v11, 205, v9
    v_lshrrev_b32 v11, 10, v11
    v_mul_u32_u24 v12, 5, v11
    v_sub_u32 v14, v9, v12
    v_mul_u32_u24 v11, 5120, v11
    v_add_u32 v11, v11, v18
    v_lshrrev_b32 v12, 1, v14
    v_lshlrev_b32 v12, 9, v12
    v_and_b32 v13, 1, v14
    v_lshl_add_u32 v12, v13, 3, v12
    v_cmp_eq_u32 vcc, 4, v14
    v_add_u32 v12, s46, v12
    v_mov_b32 v16, 2048
    v_cndmask_b32 v12, v12, v15, vcc
    v_cndmask_b32 v16, v16, v17, vcc
    v_add_u32 v66, v11, v12
    v_add_u32 v67, v66, v16
    v_add_u32 v9, 4, v9
    v_mul_u32_u24 v11, 205, v9
    v_lshrrev_b32 v11, 10, v11
    v_mul_u32_u24 v12, 5, v11
    v_sub_u32 v14, v9, v12
    v_mul_u32_u24 v11, 5120, v11
    v_add_u32 v11, v11, v18
    v_lshrrev_b32 v12, 1, v14
    v_lshlrev_b32 v12, 9, v12
    v_and_b32 v13, 1, v14
    v_lshl_add_u32 v12, v13, 3, v12
    v_cmp_eq_u32 vcc, 4, v14
    v_add_u32 v12, s46, v12
    v_mov_b32 v16, 2048
    v_cndmask_b32 v12, v12, v15, vcc
    v_cndmask_b32 v16, v16, v17, vcc
    v_add_u32 v68, v11, v12
    v_add_u32 v69, v68, v16
    s_mul_i32 s44, s36, 3072
    s_add_u32 s44, s44, 147456
    v_lshl_add_u32 v6, v1, 2, s44
    ds_write_b32 v6, v60 offset:0
    ds_write_b32 v6, v61 offset:256
    ds_write_b32 v6, v62 offset:512
    ds_write_b32 v6, v63 offset:768
    ds_write_b32 v6, v64 offset:1024
    ds_write_b32 v6, v65 offset:1280
    ds_write_b32 v6, v66 offset:1536
    ds_write_b32 v6, v67 offset:1792
    ds_write_b32 v6, v68 offset:2048
    ds_write_b32 v6, v69 offset:2304
    ds_write_b32 v6, v70 offset:2560
    ds_write_b32 v6, v71 offset:2816
    s_waitcnt lgkmcnt(0)
    s_barrier
    ds_read_b64_tr_b16 v[32:33], v4 offset:0
    ds_read_b64_tr_b16 v[34:35], v4 offset:1280
    ds_read_b128 v[16:19], v2 offset:0
    ds_read_b128 v[20:23], v2 offset:2048
    ds_read_b128 v[24:27], v2 offset:8192
    ds_read_b128 v[28:31], v2 offset:10240
    ds_read_b64_tr_b16 v[36:37], v5 offset:32
    ds_read_b64_tr_b16 v[38:39], v5 offset:1312
    ds_read_b64_tr_b16 v[40:41], v4 offset:64
    ds_read_b64_tr_b16 v[42:43], v4 offset:1344
    ds_read_b64_tr_b16 v[44:45], v5 offset:96
    ds_read_b64_tr_b16 v[46:47], v5 offset:1376
    ds_read_b64_tr_b16 v[48:49], v4 offset:128
    ds_read_b64_tr_b16 v[50:51], v4 offset:1408
L_k1_loop1:
    s_waitcnt lgkmcnt(0)
    v_mfma_f32_16x16x32_bf16 v[88:91], v[32:35], v[16:19], v[88:91]
    ds_read_b64_tr_b16 v[68:69], v4 offset:10240
    v_mfma_f32_16x16x32_bf16 v[108:111], v[32:35], v[20:23], v[108:111]
    ds_read_b64_tr_b16 v[70:71], v4 offset:11520
    v_mfma_f32_16x16x32_bf16 v[128:131], v[32:35], v[24:27], v[128:131]
    ds_read_b128 v[52:55], v3 offset:0
    v_mfma_f32_16x16x32_bf16 v[148:151], v[32:35], v[28:31], v[148:151]
    ds_read_b128 v[56:59], v3 offset:2048
    v_mfma_f32_16x16x32_bf16 v[92:95], v[36:39], v[16:19], v[92:95]
    ds_read_b128 v[60:63], v3 offset:8192
    v_mfma_f32_16x16x32_bf16 v[112:115], v[36:39], v[20:23], v[112:115]
    ds_read_b128 v[64:67], v3 offset:10240
    v_mfma_f32_16x16x32_bf16 v[132:135], v[36:39], v[24:27], v[132:135]
    ds_read_b64_tr_b16 v[72:73], v5 offset:10272
    v_mfma_f32_16x16x32_bf16 v[152:155], v[36:39], v[28:31], v[152:155]
    ds_read_b64_tr_b16 v[74:75], v5 offset:11552
    v_mfma_f32_16x16x32_bf16 v[96:99], v[40:43], v[16:19], v[96:99]
    ds_read_b64_tr_b16 v[76:77], v4 offset:10304
    v_mfma_f32_16x16x32_bf16 v[116:119], v[40:43], v[20:23], v[116:119]
    ds_read_b64_tr_b16 v[78:79], v4 offset:11584
    v_mfma_f32_16x16x32_bf16 v[136:139], v[40:43], v[24:27], v[136:139]
    ds_read_b64_tr_b16 v[80:81], v5 offset:10336
    v_mfma_f32_16x16x32_bf16 v[156:159], v[40:43], v[28:31], v[156:159]
    ds_read_b64_tr_b16 v[82:83], v5 offset:11616
    v_mfma_f32_16x16x32_bf16 v[100:103], v[44:47], v[16:19], v[100:103]
    ds_read_b64_tr_b16 v[84:85], v4 offset:10368
    v_mfma_f32_16x16x32_bf16 v[120:123], v[44:47], v[20:23], v[120:123]
    ds_read_b64_tr_b16 v[86:87], v4 offset:11648
    v_mfma_f32_16x16x32_bf16 v[140:143], v[44:47], v[24:27], v[140:143]
    v_mfma_f32_16x16x32_bf16 v[160:163], v[44:47], v[28:31], v[160:163]
    v_mfma_f32_16x16x32_bf16 v[104:107], v[48:51], v[16:19], v[104:107]
    v_mfma_f32_16x16x32_bf16 v[124:127], v[48:51], v[20:23], v[124:127]
    v_mfma_f32_16x16x32_bf16 v[144:147], v[48:51], v[24:27], v[144:147]
    v_mfma_f32_16x16x32_bf16 v[164:167], v[48:51], v[28:31], v[164:167]
    s_add_u32 s65, s65, 1
    s_cmp_eq_u32 s65, 10
    s_cbranch_scc1 L_k1_loop1_last
    s_add_u32 s66, s66, 1
    s_mov_b32 s64, 36864
    s_cmp_eq_u32 s66, 4
    s_cselect_b32 s64, 4294856704, s64
    s_cselect_b32 s66, 0, s66
    v_add_u32 v2, s64, v2
    v_add_u32 v3, s64, v3
    v_add_u32 v4, s64, v4
    v_add_u32 v5, s64, v5
    s_waitcnt lgkmcnt(0)
    s_barrier
    v_mfma_f32_16x16x32_bf16 v[88:91], v[68:71], v[52:55], v[88:91]
    ds_read_b64_tr_b16 v[32:33], v4 offset:0
    v_mfma_f32_16x16x32_bf16 v[108:111], v[68:71], v[56:59], v[108:111]
    ds_read_b64_tr_b16 v[34:35], v4 offset:1280
    v_mfma_f32_16x16x32_bf16 v[128:131], v[68:71], v[60:63], v[128:131]
    ds_read_b128 v[16:19], v2 offset:0
    v_mfma_f32_16x16x32_bf16 v[148:151], v[68:71], v[64:67], v[148:151]
    ds_read_b128 v[20:23], v2 offset:2048
    v_mfma_f32_16x16x32_bf16 v[92:95], v[72:75], v[52:55], v[92:95]
    ds_read_b128 v[24:27], v2 offset:8192
    v_mfma_f32_16x16x32_bf16 v[112:115], v[72:75], v[56:59], v[112:115]
    ds_read_b128 v[28:31], v2 offset:10240
    v_mfma_f32_16x16x32_bf16 v[132:135], v[72:75], v[60:63], v[132:135]
    ds_read_b64_tr_b16 v[36:37], v5 offset:32
    v_mfma_f32_16x16x32_bf16 v[152:155], v[72:75], v[64:67], v[152:155]
    ds_read_b64_tr_b16 v[38:39], v5 offset:1312
    v_mfma_f32_16x16x32_bf16 v[96:99], v[76:79], v[52:55], v[96:99]
    ds_read_b64_tr_b16 v[40:41], v4 offset:64
    v_mfma_f32_16x16x32_bf16 v[116:119], v[76:79], v[56:59], v[116:119]
    ds_read_b64_tr_b16 v[42:43], v4 offset:1344
    v_mfma_f32_16x16x32_bf16 v[136:139], v[76:79], v[60:63], v[136:139]
    ds_read_b64_tr_b16 v[44:45], v5 offset:96
    v_mfma_f32_16x16x32_bf16 v[156:159], v[76:79], v[64:67], v[156:159]
    ds_read_b64_tr_b16 v[46:47], v5 offset:1376
    v_mfma_f32_16x16x32_bf16 v[100:103], v[80:83], v[52:55], v[100:103]
    ds_read_b64_tr_b16 v[48:49], v4 offset:128
    v_mfma_f32_16x16x32_bf16 v[120:123], v[80:83], v[56:59], v[120:123]
    ds_read_b64_tr_b16 v[50:51], v4 offset:1408
    v_mfma_f32_16x16x32_bf16 v[140:143], v[80:83], v[60:63], v[140:143]
    v_mfma_f32_16x16x32_bf16 v[160:163], v[80:83], v[64:67], v[160:163]
    v_mfma_f32_16x16x32_bf16 v[104:107], v[84:87], v[52:55], v[104:107]
    v_mfma_f32_16x16x32_bf16 v[124:127], v[84:87], v[56:59], v[124:127]
    v_mfma_f32_16x16x32_bf16 v[144:147], v[84:87], v[60:63], v[144:147]
    v_mfma_f32_16x16x32_bf16 v[164:167], v[84:87], v[64:67], v[164:167]
    s_branch L_k1_loop1
L_k1_loop1_last:
    s_waitcnt lgkmcnt(0)
    v_mfma_f32_16x16x32_bf16 v[88:91], v[68:71], v[52:55], v[88:91]
    v_mfma_f32_16x16x32_bf16 v[108:111], v[68:71], v[56:59], v[108:111]
    v_mfma_f32_16x16x32_bf16 v[128:131], v[68:71], v[60:63], v[128:131]
    v_mfma_f32_16x16x32_bf16 v[148:151], v[68:71], v[64:67], v[148:151]
    v_mfma_f32_16x16x32_bf16 v[92:95], v[72:75], v[52:55], v[92:95]
    v_mfma_f32_16x16x32_bf16 v[112:115], v[72:75], v[56:59], v[112:115]
    v_mfma_f32_16x16x32_bf16 v[132:135], v[72:75], v[60:63], v[132:135]
    v_mfma_f32_16x16x32_bf16 v[152:155], v[72:75], v[64:67], v[152:155]
    v_mfma_f32_16x16x32_bf16 v[96:99], v[76:79], v[52:55], v[96:99]
    v_mfma_f32_16x16x32_bf16 v[116:119], v[76:79], v[56:59], v[116:119]
    v_mfma_f32_16x16x32_bf16 v[136:139], v[76:79], v[60:63], v[136:139]
    v_mfma_f32_16x16x32_bf16 v[156:159], v[76:79], v[64:67], v[156:159]
    v_mfma_f32_16x16x32_bf16 v[100:103], v[80:83], v[52:55], v[100:103]
    v_mfma_f32_16x16x32_bf16 v[120:123], v[80:83], v[56:59], v[120:123]
    v_mfma_f32_16x16x32_bf16 v[140:143], v[80:83], v[60:63], v[140:143]
    v_mfma_f32_16x16x32_bf16 v[160:163], v[80:83], v[64:67], v[160:163]
    v_mfma_f32_16x16x32_bf16 v[104:107], v[84:87], v[52:55], v[104:107]
    v_mfma_f32_16x16x32_bf16 v[124:127], v[84:87], v[56:59], v[124:127]
    v_mfma_f32_16x16x32_bf16 v[144:147], v[84:87], v[60:63], v[144:147]
    v_mfma_f32_16x16x32_bf16 v[164:167], v[84:87], v[64:67], v[164:167]
    ds_read_b32 v72, v6 offset:0
    ds_read_b32 v73, v6 offset:256
    ds_read_b32 v74, v6 offset:512
    ds_read_b32 v75, v6 offset:768
    ds_read_b32 v76, v6 offset:1024
    ds_read_b32 v77, v6 offset:1280
    ds_read_b32 v78, v6 offset:1536
    ds_read_b32 v79, v6 offset:1792
    ds_read_b32 v80, v6 offset:2048
    ds_read_b32 v81, v6 offset:2304
    ds_read_b32 v82, v6 offset:2560
    ds_read_b32 v83, v6 offset:2816
    s_waitcnt lgkmcnt(0)
    s_cmp_ge_u32 s38, 4
    s_mov_b32 s48, 1051011932
    s_nop 5
    s_cbranch_scc1 L_noscale_3
    v_mul_f32 v88, s48, v88
    v_mul_f32 v89, s48, v89
    v_mul_f32 v90, s48, v90
    v_mul_f32 v91, s48, v91
    v_mul_f32 v92, s48, v92
    v_mul_f32 v93, s48, v93
    v_mul_f32 v94, s48, v94
    v_mul_f32 v95, s48, v95
    v_mul_f32 v96, s48, v96
    v_mul_f32 v97, s48, v97
    v_mul_f32 v98, s48, v98
    v_mul_f32 v99, s48, v99
    v_mul_f32 v100, s48, v100
    v_mul_f32 v101, s48, v101
    v_mul_f32 v102, s48, v102
    v_mul_f32 v103, s48, v103
    v_mul_f32 v104, s48, v104
    v_mul_f32 v105, s48, v105
    v_mul_f32 v106, s48, v106
    v_mul_f32 v107, s48, v107
    v_mul_f32 v108, s48, v108
    v_mul_f32 v109, s48, v109
    v_mul_f32 v110, s48, v110
    v_mul_f32 v111, s48, v111
    v_mul_f32 v112, s48, v112
    v_mul_f32 v113, s48, v113
    v_mul_f32 v114, s48, v114
    v_mul_f32 v115, s48, v115
    v_mul_f32 v116, s48, v116
    v_mul_f32 v117, s48, v117
    v_mul_f32 v118, s48, v118
    v_mul_f32 v119, s48, v119
    v_mul_f32 v120, s48, v120
    v_mul_f32 v121, s48, v121
    v_mul_f32 v122, s48, v122
    v_mul_f32 v123, s48, v123
    v_mul_f32 v124, s48, v124
    v_mul_f32 v125, s48, v125
    v_mul_f32 v126, s48, v126
    v_mul_f32 v127, s48, v127
    v_mul_f32 v128, s48, v128
    v_mul_f32 v129, s48, v129
    v_mul_f32 v130, s48, v130
    v_mul_f32 v131, s48, v131
    v_mul_f32 v132, s48, v132
    v_mul_f32 v133, s48, v133
    v_mul_f32 v134, s48, v134
    v_mul_f32 v135, s48, v135
    v_mul_f32 v136, s48, v136
    v_mul_f32 v137, s48, v137
    v_mul_f32 v138, s48, v138
    v_mul_f32 v139, s48, v139
    v_mul_f32 v140, s48, v140
    v_mul_f32 v141, s48, v141
    v_mul_f32 v142, s48, v142
    v_mul_f32 v143, s48, v143
    v_mul_f32 v144, s48, v144
    v_mul_f32 v145, s48, v145
    v_mul_f32 v146, s48, v146
    v_mul_f32 v147, s48, v147
    v_mul_f32 v148, s48, v148
    v_mul_f32 v149, s48, v149
    v_mul_f32 v150, s48, v150
    v_mul_f32 v151, s48, v151
    v_mul_f32 v152, s48, v152
    v_mul_f32 v153, s48, v153
    v_mul_f32 v154, s48, v154
    v_mul_f32 v155, s48, v155
    v_mul_f32 v156, s48, v156
    v_mul_f32 v157, s48, v157
    v_mul_f32 v158, s48, v158
    v_mul_f32 v159, s48, v159
    v_mul_f32 v160, s48, v160
    v_mul_f32 v161, s48, v161
    v_mul_f32 v162, s48, v162
    v_mul_f32 v163, s48, v163
    v_mul_f32 v164, s48, v164
    v_mul_f32 v165, s48, v165
    v_mul_f32 v166, s48, v166
    v_mul_f32 v167, s48, v167
L_noscale_3:
    v_cvt_pk_bf16_f32 v20, v88, v89
    v_cvt_pk_bf16_f32 v21, v90, v91
    ds_write_b64 v72, v[20:21] offset:0
    v_cvt_pk_bf16_f32 v22, v108, v109
    v_cvt_pk_bf16_f32 v23, v110, v111
    ds_write_b64 v72, v[22:23] offset:256
    v_cvt_pk_bf16_f32 v24, v128, v129
    v_cvt_pk_bf16_f32 v25, v130, v131
    ds_write_b64 v73, v[24:25] offset:0
    v_cvt_pk_bf16_f32 v26, v148, v149
    v_cvt_pk_bf16_f32 v27, v150, v151
    ds_write_b64 v73, v[26:27] offset:256
    v_cvt_pk_bf16_f32 v28, v92, v93
    v_cvt_pk_bf16_f32 v29, v94, v95
    ds_write_b64 v74, v[28:29] offset:0
    v_cvt_pk_bf16_f32 v30, v112, v113
    v_cvt_pk_bf16_f32 v31, v114, v115
    ds_write_b64 v74, v[30:31] offset:256
    v_cvt_pk_bf16_f32 v32, v132, v133
    v_cvt_pk_bf16_f32 v33, v134, v135
    ds_write_b64 v75, v[32:33] offset:0
    v_cvt_pk_bf16_f32 v34, v152, v153
    v_cvt_pk_bf16_f32 v35, v154, v155
    ds_write_b64 v75, v[34:35] offset:256
    v_cvt_pk_bf16_f32 v36, v96, v97
    v_cvt_pk_bf16_f32 v37, v98, v99
    ds_write_b64 v76, v[36:37] offset:0
    v_cvt_pk_bf16_f32 v38, v116, v117
    v_cvt_pk_bf16_f32 v39, v118, v119
    ds_write_b64 v76, v[38:39] offset:256
    v_cvt_pk_bf16_f32 v40, v136, v137
    v_cvt_pk_bf16_f32 v41, v138, v139
    ds_write_b64 v77, v[40:41] offset:0
    v_cvt_pk_bf16_f32 v42, v156, v157
    v_cvt_pk_bf16_f32 v43, v158, v159
    ds_write_b64 v77, v[42:43] offset:256
    v_cvt_pk_bf16_f32 v44, v100, v101
    v_cvt_pk_bf16_f32 v45, v102, v103
    ds_write_b64 v78, v[44:45] offset:0
    v_cvt_pk_bf16_f32 v46, v120, v121
    v_cvt_pk_bf16_f32 v47, v122, v123
    ds_write_b64 v78, v[46:47] offset:256
    v_cvt_pk_bf16_f32 v48, v140, v141
    v_cvt_pk_bf16_f32 v49, v142, v143
    ds_write_b64 v79, v[48:49] offset:0
    v_cvt_pk_bf16_f32 v50, v160, v161
    v_cvt_pk_bf16_f32 v51, v162, v163
    ds_write_b64 v79, v[50:51] offset:256
    v_cvt_pk_bf16_f32 v52, v104, v105
    v_cvt_pk_bf16_f32 v53, v106, v107
    ds_write_b64 v80, v[52:53] offset:0
    v_cvt_pk_bf16_f32 v54, v124, v125
    v_cvt_pk_bf16_f32 v55, v126, v127
    ds_write_b64 v80, v[54:55] offset:256
    v_cvt_pk_bf16_f32 v56, v144, v145
    v_cvt_pk_bf16_f32 v57, v146, v147
    ds_write_b64 v81, v[56:57] offset:0
    v_cvt_pk_bf16_f32 v58, v164, v165
    v_cvt_pk_bf16_f32 v59, v166, v167
    ds_write_b64 v81, v[58:59] offset:256
    s_branch L_k1_copy
L_k1_c1:
    s_cmp_ge_u32 s38, 12
    s_cbranch_scc1 L_k1_c1d
    v_and_b32 v8, 15, v1
    v_lshrrev_b32 v9, 4, v1
    s_mul_i32 s45, s39, 1280
    s_add_u32 s45, s45, 73728
    v_and_b32 v10, 1, v9
    v_mul_u32_u24 v10, 320, v10
    v_lshrrev_b32 v11, 1, v9
    v_lshl_add_u32 v10, v11, 3, v10
    v_add_u32 v10, s45, v10
    s_mul_i32 s50, s40, 80
    v_add_u32 v8, s50, v8
    s_movk_i32 s51, 3277
    v_mul_u32_u24 v11, s51, v8
    v_lshrrev_b32 v11, 16, v11
    v_mul_u32_u24 v12, 20, v11
    v_sub_u32 v12, v8, v12
    v_mul_u32_u24 v11, 5120, v11
    v_lshl_add_u32 v12, v12, 4, v10
    v_add_u32 v60, v12, v11
    v_add_u32 v8, 16, v8
    v_mul_u32_u24 v11, s51, v8
    v_lshrrev_b32 v11, 16, v11
    v_mul_u32_u24 v12, 20, v11
    v_sub_u32 v12, v8, v12
    v_mul_u32_u24 v11, 5120, v11
    v_lshl_add_u32 v12, v12, 4, v10
    v_add_u32 v61, v12, v11
    v_add_u32 v8, 16, v8
    v_mul_u32_u24 v11, s51, v8
    v_lshrrev_b32 v11, 16, v11
    v_mul_u32_u24 v12, 20, v11
    v_sub_u32 v12, v8, v12
    v_mul_u32_u24 v11, 5120, v11
    v_lshl_add_u32 v12, v12, 4, v10
    v_add_u32 v62, v12, v11
    v_add_u32 v8, 16, v8
    v_mul_u32_u24 v11, s51, v8
    v_lshrrev_b32 v11, 16, v11
    v_mul_u32_u24 v12, 20, v11
    v_sub_u32 v12, v8, v12
    v_mul_u32_u24 v11, 5120, v11
    v_lshl_add_u32 v12, v12, 4, v10
    v_add_u32 v63, v12, v11
    v_add_u32 v8, 16, v8
    v_mul_u32_u24 v11, s51, v8
    v_lshrrev_b32 v11, 16, v11
    v_mul_u32_u24 v12, 20, v11
    v_sub_u32 v12, v8, v12
    v_mul_u32_u24 v11, 5120, v11
    v_lshl_add_u32 v12, v12, 4, v10
    v_add_u32 v64, v12, v11
    s_branch L_k1_c1go
L_k1_c1d:
    v_and_b32 v8, 15, v1
    v_lshrrev_b32 v9, 4, v1
    s_lshl_b32 s45, s39, 11
    s_add_u32 s45, s45, 73728
    v_lshl_add_u32 v10, v9, 2, s45
    s_mul_i32 s50, s40, 80
    v_add_u32 v8, s50, v8
    s_cmp_lt_u32 s38, 14
    s_mov_b32 s47, 8650752
    s_cselect_b32 s47, 7864320, s47
    s_cselect_b32 s49, 1.0, -1.0
    s_and_b32 s46, s38, 1
    s_mul_i32 s46, s46, 337920
    s_add_u32 s47, s47, s46
    s_add_u32 s47, s47, 65536
    s_mov_b32 s48, 67584
    v_lshrrev_b32 v11, 5, v8
    v_and_b32 v12, 31, v8
    v_lshlrev_b32 v12, 4, v12
    v_lshl_add_u32 v13, v11, 12, v12
    v_add_u32 v60, v13, v10
    v_mul_lo_u32 v13, v11, s48
    v_add3_u32 v65, v13, v12, s47
    v_add_u32 v8, 16, v8
    v_lshrrev_b32 v11, 5, v8
    v_and_b32 v12, 31, v8
    v_lshlrev_b32 v12, 4, v12
    v_lshl_add_u32 v13, v11, 12, v12
    v_add_u32 v61, v13, v10
    v_mul_lo_u32 v13, v11, s48
    v_add3_u32 v66, v13, v12, s47
    v_add_u32 v8, 16, v8
    v_lshrrev_b32 v11, 5, v8
    v_and_b32 v12, 31, v8
    v_lshlrev_b32 v12, 4, v12
    v_lshl_add_u32 v13, v11, 12, v12
    v_add_u32 v62, v13, v10
    v_mul_lo_u32 v13, v11, s48
    v_add3_u32 v67, v13, v12, s47
    v_add_u32 v8, 16, v8
    v_lshrrev_b32 v11, 5, v8
    v_and_b32 v12, 31, v8
    v_lshlrev_b32 v12, 4, v12
    v_lshl_add_u32 v13, v11, 12, v12
    v_add_u32 v63, v13, v10
    v_mul_lo_u32 v13, v11, s48
    v_add3_u32 v68, v13, v12, s47
    v_add_u32 v8, 16, v8
    v_lshrrev_b32 v11, 5, v8
    v_and_b32 v12, 31, v8
    v_lshlrev_b32 v12, 4, v12
    v_lshl_add_u32 v13, v11, 12, v12
    v_add_u32 v64, v13, v10
    v_mul_lo_u32 v13, v11, s48
    v_add3_u32 v69, v13, v12, s47
    v_mov_b32 v70, s49
    v_mov_b32 v71, s49
L_k1_c1go:
    s_mul_i32 s44, s36, 3072
    s_add_u32 s44, s44, 147456
    v_lshl_add_u32 v6, v1, 2, s44
    ds_write_b32 v6, v60 offset:0
    ds_write_b32 v6, v61 offset:256
    ds_write_b32 v6, v62 offset:512
    ds_write_b32 v6, v63 offset:768
    ds_write_b32 v6, v64 offset:1024
    ds_write_b32 v6, v65 offset:1280
    ds_write_b32 v6, v66 offset:1536
    ds_write_b32 v6, v67 offset:1792
    ds_write_b32 v6, v68 offset:2048
    ds_write_b32 v6, v69 offset:2304
    ds_write_b32 v6, v70 offset:2560
    ds_write_b32 v6, v71 offset:2816
    s_waitcnt lgkmcnt(0)
    s_barrier
    ds_read_b64_tr_b16 v[32:33], v4 offset:0
    ds_read_b64_tr_b16 v[34:35], v4 offset:1280
    ds_read_b128 v[16:19], v2 offset:0
    ds_read_b128 v[20:23], v2 offset:2048
    ds_read_b128 v[24:27], v2 offset:8192
    ds_read_b128 v[28:31], v2 offset:10240
    ds_read_b64_tr_b16 v[36:37], v5 offset:32
    ds_read_b64_tr_b16 v[38:39], v5 offset:1312
    ds_read_b64_tr_b16 v[40:41], v4 offset:64
    ds_read_b64_tr_b16 v[42:43], v4 offset:1344
    ds_read_b64_tr_b16 v[44:45], v5 offset:96
    ds_read_b64_tr_b16 v[46:47], v5 offset:1376
    ds_read_b64_tr_b16 v[48:49], v4 offset:128
    ds_read_b64_tr_b16 v[50:51], v4 offset:1408
L_k1_loop0:
    s_waitcnt lgkmcnt(0)
    v_mfma_f32_16x16x32_bf16 v[88:91], v[16:19], v[32:35], v[88:91]
    ds_read_b64_tr_b16 v[68:69], v4 offset:10240
    v_mfma_f32_16x16x32_bf16 v[108:111], v[20:23], v[32:35], v[108:111]
    ds_read_b64_tr_b16 v[70:71], v4 offset:11520
    v_mfma_f32_16x16x32_bf16 v[128:131], v[24:27], v[32:35], v[128:131]
    ds_read_b128 v[52:55], v3 offset:0
    v_mfma_f32_16x16x32_bf16 v[148:151], v[28:31], v[32:35], v[148:151]
    ds_read_b128 v[56:59], v3 offset:2048
    v_mfma_f32_16x16x32_bf16 v[92:95], v[16:19], v[36:39], v[92:95]
    ds_read_b128 v[60:63], v3 offset:8192
    v_mfma_f32_16x16x32_bf16 v[112:115], v[20:23], v[36:39], v[112:115]
    ds_read_b128 v[64:67], v3 offset:10240
    v_mfma_f32_16x16x32_bf16 v[132:135], v[24:27], v[36:39], v[132:135]
    ds_read_b64_tr_b16 v[72:73], v5 offset:10272
    v_mfma_f32_16x16x32_bf16 v[152:155], v[28:31], v[36:39], v[152:155]
    ds_read_b64_tr_b16 v[74:75], v5 offset:11552
    v_mfma_f32_16x16x32_bf16 v[96:99], v[16:19], v[40:43], v[96:99]
    ds_read_b64_tr_b16 v[76:77], v4 offset:10304
    v_mfma_f32_16x16x32_bf16 v[116:119], v[20:23], v[40:43], v[116:119]
    ds_read_b64_tr_b16 v[78:79], v4 offset:11584
    v_mfma_f32_16x16x32_bf16 v[136:139], v[24:27], v[40:43], v[136:139]
    ds_read_b64_tr_b16 v[80:81], v5 offset:10336
    v_mfma_f32_16x16x32_bf16 v[156:159], v[28:31], v[40:43], v[156:159]
    ds_read_b64_tr_b16 v[82:83], v5 offset:11616
    v_mfma_f32_16x16x32_bf16 v[100:103], v[16:19], v[44:47], v[100:103]
    ds_read_b64_tr_b16 v[84:85], v4 offset:10368
    v_mfma_f32_16x16x32_bf16 v[120:123], v[20:23], v[44:47], v[120:123]
    ds_read_b64_tr_b16 v[86:87], v4 offset:11648
    v_mfma_f32_16x16x32_bf16 v[140:143], v[24:27], v[44:47], v[140:143]
    v_mfma_f32_16x16x32_bf16 v[160:163], v[28:31], v[44:47], v[160:163]
    v_mfma_f32_16x16x32_bf16 v[104:107], v[16:19], v[48:51], v[104:107]
    v_mfma_f32_16x16x32_bf16 v[124:127], v[20:23], v[48:51], v[124:127]
    v_mfma_f32_16x16x32_bf16 v[144:147], v[24:27], v[48:51], v[144:147]
    v_mfma_f32_16x16x32_bf16 v[164:167], v[28:31], v[48:51], v[164:167]
    s_add_u32 s65, s65, 1
    s_cmp_eq_u32 s65, 10
    s_cbranch_scc1 L_k1_loop0_last
    s_add_u32 s66, s66, 1
    s_mov_b32 s64, 36864
    s_cmp_eq_u32 s66, 4
    s_cselect_b32 s64, 4294856704, s64
    s_cselect_b32 s66, 0, s66
    v_add_u32 v2, s64, v2
    v_add_u32 v3, s64, v3
    v_add_u32 v4, s64, v4
    v_add_u32 v5, s64, v5
    s_waitcnt lgkmcnt(0)
    s_barrier
    v_mfma_f32_16x16x32_bf16 v[88:91], v[52:55], v[68:71], v[88:91]
    ds_read_b64_tr_b16 v[32:33], v4 offset:0
    v_mfma_f32_16x16x32_bf16 v[108:111], v[56:59], v[68:71], v[108:111]
    ds_read_b64_tr_b16 v[34:35], v4 offset:1280
    v_mfma_f32_16x16x32_bf16 v[128:131], v[60:63], v[68:71], v[128:131]
    ds_read_b128 v[16:19], v2 offset:0
    v_mfma_f32_16x16x32_bf16 v[148:151], v[64:67], v[68:71], v[148:151]
    ds_read_b128 v[20:23], v2 offset:2048
    v_mfma_f32_16x16x32_bf16 v[92:95], v[52:55], v[72:75], v[92:95]
    ds_read_b128 v[24:27], v2 offset:8192
    v_mfma_f32_16x16x32_bf16 v[112:115], v[56:59], v[72:75], v[112:115]
    ds_read_b128 v[28:31], v2 offset:10240
    v_mfma_f32_16x16x32_bf16 v[132:135], v[60:63], v[72:75], v[132:135]
    ds_read_b64_tr_b16 v[36:37], v5 offset:32
    v_mfma_f32_16x16x32_bf16 v[152:155], v[64:67], v[72:75], v[152:155]
    ds_read_b64_tr_b16 v[38:39], v5 offset:1312
    v_mfma_f32_16x16x32_bf16 v[96:99], v[52:55], v[76:79], v[96:99]
    ds_read_b64_tr_b16 v[40:41], v4 offset:64
    v_mfma_f32_16x16x32_bf16 v[116:119], v[56:59], v[76:79], v[116:119]
    ds_read_b64_tr_b16 v[42:43], v4 offset:1344
    v_mfma_f32_16x16x32_bf16 v[136:139], v[60:63], v[76:79], v[136:139]
    ds_read_b64_tr_b16 v[44:45], v5 offset:96
    v_mfma_f32_16x16x32_bf16 v[156:159], v[64:67], v[76:79], v[156:159]
    ds_read_b64_tr_b16 v[46:47], v5 offset:1376
    v_mfma_f32_16x16x32_bf16 v[100:103], v[52:55], v[80:83], v[100:103]
    ds_read_b64_tr_b16 v[48:49], v4 offset:128
    v_mfma_f32_16x16x32_bf16 v[120:123], v[56:59], v[80:83], v[120:123]
    ds_read_b64_tr_b16 v[50:51], v4 offset:1408
    v_mfma_f32_16x16x32_bf16 v[140:143], v[60:63], v[80:83], v[140:143]
    v_mfma_f32_16x16x32_bf16 v[160:163], v[64:67], v[80:83], v[160:163]
    v_mfma_f32_16x16x32_bf16 v[104:107], v[52:55], v[84:87], v[104:107]
    v_mfma_f32_16x16x32_bf16 v[124:127], v[56:59], v[84:87], v[124:127]
    v_mfma_f32_16x16x32_bf16 v[144:147], v[60:63], v[84:87], v[144:147]
    v_mfma_f32_16x16x32_bf16 v[164:167], v[64:67], v[84:87], v[164:167]
    s_branch L_k1_loop0
L_k1_loop0_last:
    s_waitcnt lgkmcnt(0)
    v_mfma_f32_16x16x32_bf16 v[88:91], v[52:55], v[68:71], v[88:91]
    v_mfma_f32_16x16x32_bf16 v[108:111], v[56:59], v[68:71], v[108:111]
    v_mfma_f32_16x16x32_bf16 v[128:131], v[60:63], v[68:71], v[128:131]
    v_mfma_f32_16x16x32_bf16 v[148:151], v[64:67], v[68:71], v[148:151]
    v_mfma_f32_16x16x32_bf16 v[92:95], v[52:55], v[72:75], v[92:95]
    v_mfma_f32_16x16x32_bf16 v[112:115], v[56:59], v[72:75], v[112:115]
    v_mfma_f32_16x16x32_bf16 v[132:135], v[60:63], v[72:75], v[132:135]
    v_mfma_f32_16x16x32_bf16 v[152:155], v[64:67], v[72:75], v[152:155]
    v_mfma_f32_16x16x32_bf16 v[96:99], v[52:55], v[76:79], v[96:99]
    v_mfma_f32_16x16x32_bf16 v[116:119], v[56:59], v[76:79], v[116:119]
    v_mfma_f32_16x16x32_bf16 v[136:139], v[60:63], v[76:79], v[136:139]
    v_mfma_f32_16x16x32_bf16 v[156:159], v[64:67], v[76:79], v[156:159]
    v_mfma_f32_16x16x32_bf16 v[100:103], v[52:55], v[80:83], v[100:103]
    v_mfma_f32_16x16x32_bf16 v[120:123], v[56:59], v[80:83], v[120:123]
    v_mfma_f32_16x16x32_bf16 v[140:143], v[60:63], v[80:83], v[140:143]
    v_mfma_f32_16x16x32_bf16 v[160:163], v[64:67], v[80:83], v[160:163]
    v_mfma_f32_16x16x32_bf16 v[104:107], v[52:55], v[84:87], v[104:107]
    v_mfma_f32_16x16x32_bf16 v[124:127], v[56:59], v[84:87], v[124:127]
    v_mfma_f32_16x16x32_bf16 v[144:147], v[60:63], v[84:87], v[144:147]
    v_mfma_f32_16x16x32_bf16 v[164:167], v[64:67], v[84:87], v[164:167]
    ds_read_b32 v72, v6 offset:0
    ds_read_b32 v73, v6 offset:256
    ds_read_b32 v74, v6 offset:512
    ds_read_b32 v75, v6 offset:768
    ds_read_b32 v76, v6 offset:1024
    ds_read_b32 v77, v6 offset:1280
    ds_read_b32 v78, v6 offset:1536
    ds_read_b32 v79, v6 offset:1792
    ds_read_b32 v80, v6 offset:2048
    ds_read_b32 v81, v6 offset:2304
    ds_read_b32 v82, v6 offset:2560
    ds_read_b32 v83, v6 offset:2816
    s_waitcnt lgkmcnt(0)
    s_cmp_ge_u32 s38, 12
    s_cbranch_scc1 L_k1_c2
    s_nop 7
    v_cvt_pk_bf16_f32 v20, v88, v89
    v_cvt_pk_bf16_f32 v21, v90, v91
    ds_write_b64 v72, v[20:21] offset:0
    v_cvt_pk_bf16_f32 v22, v108, v109
    v_cvt_pk_bf16_f32 v23, v110, v111
    ds_write_b64 v72, v[22:23] offset:640
    v_cvt_pk_bf16_f32 v24, v128, v129
    v_cvt_pk_bf16_f32 v25, v130, v131
    ds_write_b64 v72, v[24:25] offset:2560
    v_cvt_pk_bf16_f32 v26, v148, v149
    v_cvt_pk_bf16_f32 v27, v150, v151
    ds_write_b64 v72, v[26:27] offset:3200
    v_cvt_pk_bf16_f32 v28, v92, v93
    v_cvt_pk_bf16_f32 v29, v94, v95
    ds_write_b64 v73, v[28:29] offset:0
    v_cvt_pk_bf16_f32 v30, v112, v113
    v_cvt_pk_bf16_f32 v31, v114, v115
    ds_write_b64 v73, v[30:31] offset:640
    v_cvt_pk_bf16_f32 v32, v132, v133
    v_cvt_pk_bf16_f32 v33, v134, v135
    ds_write_b64 v73, v[32:33] offset:2560
    v_cvt_pk_bf16_f32 v34, v152, v153
    v_cvt_pk_bf16_f32 v35, v154, v155
    ds_write_b64 v73, v[34:35] offset:3200
    v_cvt_pk_bf16_f32 v36, v96, v97
    v_cvt_pk_bf16_f32 v37, v98, v99
    ds_write_b64 v74, v[36:37] offset:0
    v_cvt_pk_bf16_f32 v38, v116, v117
    v_cvt_pk_bf16_f32 v39, v118, v119
    ds_write_b64 v74, v[38:39] offset:640
    v_cvt_pk_bf16_f32 v40, v136, v137
    v_cvt_pk_bf16_f32 v41, v138, v139
    ds_write_b64 v74, v[40:41] offset:2560
    v_cvt_pk_bf16_f32 v42, v156, v157
    v_cvt_pk_bf16_f32 v43, v158, v159
    ds_write_b64 v74, v[42:43] offset:3200
    v_cvt_pk_bf16_f32 v44, v100, v101
    v_cvt_pk_bf16_f32 v45, v102, v103
    ds_write_b64 v75, v[44:45] offset:0
    v_cvt_pk_bf16_f32 v46, v120, v121
    v_cvt_pk_bf16_f32 v47, v122, v123
    ds_write_b64 v75, v[46:47] offset:640
    v_cvt_pk_bf16_f32 v48, v140, v141
    v_cvt_pk_bf16_f32 v49, v142, v143
    ds_write_b64 v75, v[48:49] offset:2560
    v_cvt_pk_bf16_f32 v50, v160, v161
    v_cvt_pk_bf16_f32 v51, v162, v163
    ds_write_b64 v75, v[50:51] offset:3200
    v_cvt_pk_bf16_f32 v52, v104, v105
    v_cvt_pk_bf16_f32 v53, v106, v107
    ds_write_b64 v76, v[52:53] offset:0
    v_cvt_pk_bf16_f32 v54, v124, v125
    v_cvt_pk_bf16_f32 v55, v126, v127
    ds_write_b64 v76, v[54:55] offset:640
    v_cvt_pk_bf16_f32 v56, v144, v145
    v_cvt_pk_bf16_f32 v57, v146, v147
    ds_write_b64 v76, v[56:57] offset:2560
    v_cvt_pk_bf16_f32 v58, v164, v165
    v_cvt_pk_bf16_f32 v59, v166, v167
    ds_write_b64 v76, v[58:59] offset:3200
    s_branch L_k1_copy
L_k1_c2:
    s_lshl_b32 s50, s40, 4
    s_add_u32 s50, s50, s38
    v_and_b32 v2, 15, v1
    s_cmp_lg_u32 s50, 14
    s_cbranch_scc1 L_nospec_5
    v_cmp_eq_u32 vcc, 0, v2
    v_mov_b32 v3, 8605696
    s_nop 0
    v_cndmask_b32 v77, v77, v3, vcc
    v_cndmask_b32 v82, v82, 1.0, vcc
L_nospec_5:
    s_or_b32 s51, s37, s39
    s_cmp_lg_u32 s51, 0
    s_nop 3
    s_cbranch_scc1 L_nos0_6
    s_mov_b64 exec, 0xffff
    v_mov_b32 v9, 0
    v_mov_b32 v10, 0
    v_mov_b32 v11, 0
    v_mov_b32 v12, 0
    v_mov_b32 v13, 0
    v_mov_b32 v14, 0
    v_mov_b32 v15, 0
    v_cvt_pk_bf16_f32 v8, v128, 0
    v_mov_b32 v128, 0
    buffer_store_dwordx4 v[8:11], v77, s[20:23], 0 offen sc1
    buffer_store_dwordx4 v[12:15], v77, s[20:23], 0 offen offset:512 sc1
    s_nop 1
    v_cvt_pk_bf16_f32 v8, v132, 0
    v_mov_b32 v132, 0
    buffer_store_dwordx4 v[8:11], v78, s[20:23], 0 offen sc1
    buffer_store_dwordx4 v[12:15], v78, s[20:23], 0 offen offset:512 sc1
    s_nop 1
    v_cvt_pk_bf16_f32 v8, v136, 0
    v_mov_b32 v136, 0
    buffer_store_dwordx4 v[8:11], v79, s[20:23], 0 offen sc1
    buffer_store_dwordx4 v[12:15], v79, s[20:23], 0 offen offset:512 sc1
    s_nop 1
    v_cvt_pk_bf16_f32 v8, v140, 0
    v_mov_b32 v140, 0
    buffer_store_dwordx4 v[8:11], v80, s[20:23], 0 offen sc1
    buffer_store_dwordx4 v[12:15], v80, s[20:23], 0 offen offset:512 sc1
    s_nop 1
    v_cvt_pk_bf16_f32 v8, v144, 0
    v_mov_b32 v144, 0
    buffer_store_dwordx4 v[8:11], v81, s[20:23], 0 offen sc1
    buffer_store_dwordx4 v[12:15], v81, s[20:23], 0 offen offset:512 sc1
    s_nop 1
    s_mov_b64 exec, -1
L_nos0_6:
    v_fma_f32 v88, v128, v82, v88
    v_fma_f32 v89, v129, v82, v89
    v_fma_f32 v90, v130, v82, v90
    v_fma_f32 v91, v131, v82, v91
    v_cvt_pk_bf16_f32 v20, v88, v90
    v_cvt_pk_bf16_f32 v21, v89, v91
    ds_write_b32 v72, v20 offset:0
    ds_write_b32 v72, v21 offset:1024
    v_fma_f32 v108, v148, v82, v108
    v_fma_f32 v109, v149, v82, v109
    v_fma_f32 v110, v150, v82, v110
    v_fma_f32 v111, v151, v82, v111
    v_cvt_pk_bf16_f32 v22, v108, v110
    v_cvt_pk_bf16_f32 v23, v109, v111
    ds_write_b32 v72, v22 offset:512
    ds_write_b32 v72, v23 offset:1536
    v_fma_f32 v92, v132, v83, v92
    v_fma_f32 v93, v133, v83, v93
    v_fma_f32 v94, v134, v83, v94
    v_fma_f32 v95, v135, v83, v95
    v_cvt_pk_bf16_f32 v24, v92, v94
    v_cvt_pk_bf16_f32 v25, v93, v95
    ds_write_b32 v73, v24 offset:0
    ds_write_b32 v73, v25 offset:1024
    v_fma_f32 v112, v152, v83, v112
    v_fma_f32 v113, v153, v83, v113
    v_fma_f32 v114, v154, v83, v114
    v_fma_f32 v115, v155, v83, v115
    v_cvt_pk_bf16_f32 v26, v112, v114
    v_cvt_pk_bf16_f32 v27, v113, v115
    ds_write_b32 v73, v26 offset:512
    ds_write_b32 v73, v27 offset:1536
    v_fma_f32 v96, v136, v83, v96
    v_fma_f32 v97, v137, v83, v97
    v_fma_f32 v98, v138, v83, v98
    v_fma_f32 v99, v139, v83, v99
    v_cvt_pk_bf16_f32 v28, v96, v98
    v_cvt_pk_bf16_f32 v29, v97, v99
    ds_write_b32 v74, v28 offset:0
    ds_write_b32 v74, v29 offset:1024
    v_fma_f32 v116, v156, v83, v116
    v_fma_f32 v117, v157, v83, v117
    v_fma_f32 v118, v158, v83, v118
    v_fma_f32 v119, v159, v83, v119
    v_cvt_pk_bf16_f32 v30, v116, v118
    v_cvt_pk_bf16_f32 v31, v117, v119
    ds_write_b32 v74, v30 offset:512
    ds_write_b32 v74, v31 offset:1536
    v_fma_f32 v100, v140, v83, v100
    v_fma_f32 v101, v141, v83, v101
    v_fma_f32 v102, v142, v83, v102
    v_fma_f32 v103, v143, v83, v103
    v_cvt_pk_bf16_f32 v32, v100, v102
    v_cvt_pk_bf16_f32 v33, v101, v103
    ds_write_b32 v75, v32 offset:0
    ds_write_b32 v75, v33 offset:1024
    v_fma_f32 v120, v160, v83, v120
    v_fma_f32 v121, v161, v83, v121
    v_fma_f32 v122, v162, v83, v122
    v_fma_f32 v123, v163, v83, v123
    v_cvt_pk_bf16_f32 v34, v120, v122
    v_cvt_pk_bf16_f32 v35, v121, v123
    ds_write_b32 v75, v34 offset:512
    ds_write_b32 v75, v35 offset:1536
    v_fma_f32 v104, v144, v83, v104
    v_fma_f32 v105, v145, v83, v105
    v_fma_f32 v106, v146, v83, v106
    v_fma_f32 v107, v147, v83, v107
    v_cvt_pk_bf16_f32 v36, v104, v106
    v_cvt_pk_bf16_f32 v37, v105, v107
    ds_write_b32 v76, v36 offset:0
    ds_write_b32 v76, v37 offset:1024
    v_fma_f32 v124, v164, v83, v124
    v_fma_f32 v125, v165, v83, v125
    v_fma_f32 v126, v166, v83, v126
    v_fma_f32 v127, v167, v83, v127
    v_cvt_pk_bf16_f32 v38, v124, v126
    v_cvt_pk_bf16_f32 v39, v125, v127
    ds_write_b32 v76, v38 offset:512
    ds_write_b32 v76, v39 offset:1536
    s_cmp_lg_u32 s50, 14
    s_cbranch_scc1 L_k1_copy
    v_lshrrev_b32 v3, 4, v1
    v_lshlrev_b32 v4, 2, v3
    s_lshl_b32 s44, s37, 12
    s_lshl_b32 s45, s39, 11
    s_add_u32 s44, s44, s45
    s_add_u32 s44, s44, 8540160
    v_cmp_eq_u32 vcc, 0, v2
    s_and_saveexec_b64 s[58:59], vcc
    buffer_store_dword v20, v4, s[20:23], s44 offen offset:0 sc1
    buffer_store_dword v21, v4, s[20:23], s44 offen offset:1024 sc1
    buffer_store_dword v22, v4, s[20:23], s44 offen offset:512 sc1
    buffer_store_dword v23, v4, s[20:23], s44 offen offset:1536 sc1
    s_mov_b64 exec, -1
    s_branch L_k1_copy
L_k1_loader:
    s_sub_u32 s40, s36, 4
    s_mov_b32 s69, s38
    s_mul_i32 s44, s69, 205
    s_lshr_b32 s44, s44, 11
    s_mul_i32 s44, s44, 10
    s_sub_u32 s69, s69, s44
    v_lshrrev_b32 v2, 3, v1
    v_and_b32 v3, 7, v1
    v_lshrrev_b32 v4, 4, v1
    v_xor_b32 v3, v3, v4
    s_lshl_b32 s44, s37, 6
    s_and_b32 s45, s40, 1
    s_lshl_b32 s45, s45, 5
    s_add_u32 s44, s44, s45
    v_add_u32 v5, s44, v2
    s_cmp_ge_u32 s40, 2
    s_movk_i32 s46, 1280
    s_cselect_b32 s46, 4294966016, s46
    s_cselect_b32 s47, 2621440, 0
    v_mul_lo_u32 v6, v5, s46
    v_add_u32 v6, s47, v6
    s_lshl_b32 s46, s46, 3
    v_lshl_add_u32 v20, v3, 4, v6
    v_xor_b32 v3, 4, v3
    v_add_u32 v6, s46, v6
    v_lshl_add_u32 v21, v3, 4, v6
    s_lshl_b32 s46, s46, 1
    v_add_u32 v22, s46, v20
    v_add_u32 v23, s46, v21
    v_subrev_u32 v7, 1310720, v20
    v_cmp_le_u32 vcc, 2621440, v20
    s_lshl_b32 s48, s40, 12
    s_mul_i32 s49, s40, 5120
    v_cndmask_b32 v20, v20, v7, vcc
    s_add_u32 s49, s49, 16384
    s_lshl_b32 s61, s69, 7
    s_add_u32 m0, s48, 0
    s_nop 0
    buffer_load_dwordx4 v20, s[8:11], s61 offen lds
    s_add_u32 m0, s48, 1024
    s_nop 0
    buffer_load_dwordx4 v21, s[8:11], s61 offen lds
    s_add_u32 m0, s48, 2048
    s_nop 0
    buffer_load_dwordx4 v22, s[8:11], s61 offen lds
    s_add_u32 m0, s48, 3072
    s_nop 0
    buffer_load_dwordx4 v23, s[8:11], s61 offen lds
    s_mul_i32 s50, s40, 320
    s_movk_i32 s51, 3277
    v_add_u32 v2, s50, v1
    v_mul_u32_u24 v3, s51, v2
    v_lshrrev_b32 v3, 16, v3
    v_mul_u32_u24 v4, 20, v3
    v_sub_u32 v4, v2, v4
    v_bfe_u32 v5, v3, 3, 1
    v_lshlrev_b32 v5, 1, v5
    v_xor_b32 v4, v4, v5
    v_mul_lo_u32 v6, v3, s41
    v_lshl_add_u32 v6, v4, 4, v6
    v_add_u32 v24, s42, v6
    v_add_u32 v2, s50, v1
    v_add_u32 v2, 64, v2
    v_mul_u32_u24 v3, s51, v2
    v_lshrrev_b32 v3, 16, v3
    v_mul_u32_u24 v4, 20, v3
    v_sub_u32 v4, v2, v4
    v_bfe_u32 v5, v3, 3, 1
    v_lshlrev_b32 v5, 1, v5
    v_xor_b32 v4, v4, v5
    v_mul_lo_u32 v6, v3, s41
    v_lshl_add_u32 v6, v4, 4, v6
    v_add_u32 v25, s42, v6
    v_add_u32 v2, s50, v1
    v_add_u32 v2, 128, v2
    v_mul_u32_u24 v3, s51, v2
    v_lshrrev_b32 v3, 16, v3
    v_mul_u32_u24 v4, 20, v3
    v_sub_u32 v4, v2, v4
    v_bfe_u32 v5, v3, 3, 1
    v_lshlrev_b32 v5, 1, v5
    v_xor_b32 v4, v4, v5
    v_mul_lo_u32 v6, v3, s41
    v_lshl_add_u32 v6, v4, 4, v6
    v_add_u32 v26, s42, v6
    v_add_u32 v2, s50, v1
    v_add_u32 v2, 192, v2
    v_mul_u32_u24 v3, s51, v2
    v_lshrrev_b32 v3, 16, v3
    v_mul_u32_u24 v4, 20, v3
    v_sub_u32 v4, v2, v4
    v_bfe_u32 v5, v3, 3, 1
    v_lshlrev_b32 v5, 1, v5
    v_xor_b32 v4, v4, v5
    v_mul_lo_u32 v6, v3, s41
    v_lshl_add_u32 v6, v4, 4, v6
    v_add_u32 v27, s42, v6
    v_add_u32 v2, s50, v1
    v_add_u32 v2, 256, v2
    v_mul_u32_u24 v3, s51, v2
    v_lshrrev_b32 v3, 16, v3
    v_mul_u32_u24 v4, 20, v3
    v_sub_u32 v4, v2, v4
    v_bfe_u32 v5, v3, 3, 1
    v_lshlrev_b32 v5, 1, v5
    v_xor_b32 v4, v4, v5
    v_mul_lo_u32 v6, v3, s41
    v_lshl_add_u32 v6, v4, 4, v6
    v_add_u32 v28, s42, v6
    s_mul_i32 s62, s63, s69
    s_add_u32 m0, s49, 0
    s_nop 0
    buffer_load_dwordx4 v24, s[12:15], s62 offen lds
    s_add_u32 m0, s49, 1024
    s_nop 0
    buffer_load_dwordx4 v25, s[12:15], s62 offen lds
    s_add_u32 m0, s49, 2048
    s_nop 0
    buffer_load_dwordx4 v26, s[12:15], s62 offen lds
    s_add_u32 m0, s49, 3072
    s_nop 0
    buffer_load_dwordx4 v27, s[12:15], s62 offen lds
    s_add_u32 m0, s49, 4096
    s_nop 0
    buffer_load_dwordx4 v28, s[12:15], s62 offen lds
    s_add_u32 s69, s69, 1
    s_cmp_eq_u32 s69, 10
    s_cselect_b32 s69, 0, s69
    s_lshl_b32 s61, s69, 7
    s_add_u32 m0, s48, 36864
    s_nop 0
    buffer_load_dwordx4 v20, s[8:11], s61 offen lds
    s_add_u32 m0, s48, 37888
    s_nop 0
    buffer_load_dwordx4 v21, s[8:11], s61 offen lds
    s_add_u32 m0, s48, 38912
    s_nop 0
    buffer_load_dwordx4 v22, s[8:11], s61 offen lds
    s_add_u32 m0, s48, 39936
    s_nop 0
    buffer_load_dwordx4 v23, s[8:11], s61 offen lds
    s_mul_i32 s62, s63, s69
    s_add_u32 m0, s49, 36864
    s_nop 0
    buffer_load_dwordx4 v24, s[12:15], s62 offen lds
    s_add_u32 m0, s49, 37888
    s_nop 0
    buffer_load_dwordx4 v25, s[12:15], s62 offen lds
    s_add_u32 m0, s49, 38912
    s_nop 0
    buffer_load_dwordx4 v26, s[12:15], s62 offen lds
    s_add_u32 m0, s49, 39936
    s_nop 0
    buffer_load_dwordx4 v27, s[12:15], s62 offen lds
    s_add_u32 m0, s49, 40960
    s_nop 0
    buffer_load_dwordx4 v28, s[12:15], s62 offen lds
    s_add_u32 s69, s69, 1
    s_cmp_eq_u32 s69, 10
    s_cselect_b32 s69, 0, s69
    v_and_b32 v2, 15, v1
    s_lshl_b32 s50, s40, 4
    v_add_u32 v4, s50, v2
    v_bfe_u32 v5, v4, 3, 1
    v_mul_u32_u24 v30, 320, v4
    v_lshl_add_u32 v30, v5, 5, v30
    v_add_u32 v30, 16384, v30
    v_and_b32 v6, 1, v4
    v_lshlrev_b32 v6, 15, v6
    v_or_b32 v31, 0x3f80, v6
    s_waitcnt vmcnt(9)
    s_cmp_lg_u32 s38, 14
    s_cbranch_scc1 L_nopatch_7
    s_mov_b64 exec, 0xffff
    v_add_u32 v2, 0, v30
    ds_write_b16 v2, v31
    s_mov_b64 exec, -1
    s_waitcnt lgkmcnt(0)
L_nopatch_7:
    s_barrier
    s_lshl_b32 s61, s69, 7
    s_add_u32 m0, s48, 73728
    s_nop 0
    buffer_load_dwordx4 v20, s[8:11], s61 offen lds
    s_add_u32 m0, s48, 74752
    s_nop 0
    buffer_load_dwordx4 v21, s[8:11], s61 offen lds
    s_add_u32 m0, s48, 75776
    s_nop 0
    buffer_load_dwordx4 v22, s[8:11], s61 offen lds
    s_add_u32 m0, s48, 76800
    s_nop 0
    buffer_load_dwordx4 v23, s[8:11], s61 offen lds
    s_mul_i32 s62, s63, s69
    s_add_u32 m0, s49, 73728
    s_nop 0
    buffer_load_dwordx4 v24, s[12:15], s62 offen lds
    s_add_u32 m0, s49, 74752
    s_nop 0
    buffer_load_dwordx4 v25, s[12:15], s62 offen lds
    s_add_u32 m0, s49, 75776
    s_nop 0
    buffer_load_dwordx4 v26, s[12:15], s62 offen lds
    s_add_u32 m0, s49, 76800
    s_nop 0
    buffer_load_dwordx4 v27, s[12:15], s62 offen lds
    s_add_u32 m0, s49, 77824
    s_nop 0
    buffer_load_dwordx4 v28, s[12:15], s62 offen lds
    s_add_u32 s69, s69, 1
    s_cmp_eq_u32 s69, 10
    s_cselect_b32 s69, 0, s69
    s_lshl_b32 s61, s69, 7
    s_add_u32 m0, s48, 110592
    s_nop 0
    buffer_load_dwordx4 v20, s[8:11], s61 offen lds
    s_add_u32 m0, s48, 111616
    s_nop 0
    buffer_load_dwordx4 v21, s[8:11], s61 offen lds
    s_add_u32 m0, s48, 112640
    s_nop 0
    buffer_load_dwordx4 v22, s[8:11], s61 offen lds
    s_add_u32 m0, s48, 113664
    s_nop 0
    buffer_load_dwordx4 v23, s[8:11], s61 offen lds
    s_mul_i32 s62, s63, s69
    s_add_u32 m0, s49, 110592
    s_nop 0
    buffer_load_dwordx4 v24, s[12:15], s62 offen lds
    s_add_u32 m0, s49, 111616
    s_nop 0
    buffer_load_dwordx4 v25, s[12:15], s62 offen lds
    s_add_u32 m0, s49, 112640
    s_nop 0
    buffer_load_dwordx4 v26, s[12:15], s62 offen lds
    s_add_u32 m0, s49, 113664
    s_nop 0
    buffer_load_dwordx4 v27, s[12:15], s62 offen lds
    s_add_u32 m0, s49, 114688
    s_nop 0
    buffer_load_dwordx4 v28, s[12:15], s62 offen lds
    s_add_u32 s69, s69, 1
    s_cmp_eq_u32 s69, 10
    s_cselect_b32 s69, 0, s69
    s_waitcnt vmcnt(18)
    s_cmp_lg_u32 s38, 14
    s_cbranch_scc1 L_nopatch_8
    s_mov_b64 exec, 0xffff
    v_add_u32 v2, 36864, v30
    ds_write_b16 v2, v31
    s_mov_b64 exec, -1
    s_waitcnt lgkmcnt(0)
L_nopatch_8:
    s_barrier
    s_lshl_b32 s61, s69, 7
    s_add_u32 m0, s48, 0
    s_nop 0
    buffer_load_dwordx4 v20, s[8:11], s61 offen lds
    s_add_u32 m0, s48, 1024
    s_nop 0
    buffer_load_dwordx4 v21, s[8:11], s61 offen lds
    s_add_u32 m0, s48, 2048
    s_nop 0
    buffer_load_dwordx4 v22, s[8:11], s61 offen lds
    s_add_u32 m0, s48, 3072
    s_nop 0
    buffer_load_dwordx4 v23, s[8:11], s61 offen lds
    s_mul_i32 s62, s63, s69
    s_add_u32 m0, s49, 0
    s_nop 0
    buffer_load_dwordx4 v24, s[12:15], s62 offen lds
    s_add_u32 m0, s49, 1024
    s_nop 0
    buffer_load_dwordx4 v25, s[12:15], s62 offen lds
    s_add_u32 m0, s49, 2048
    s_nop 0
    buffer_load_dwordx4 v26, s[12:15], s62 offen lds
    s_add_u32 m0, s49, 3072
    s_nop 0
    buffer_load_dwordx4 v27, s[12:15], s62 offen lds
    s_add_u32 m0, s49, 4096
    s_nop 0
    buffer_load_dwordx4 v28, s[12:15], s62 offen lds
    s_add_u32 s69, s69, 1
    s_cmp_eq_u32 s69, 10
    s_cselect_b32 s69, 0, s69
    s_cmp_ge_u32 s38, 12
    s_cbranch_scc1 L_cpd_9
    s_and_b32 s44, s38, 3
    s_lshl_b32 s44, s44, 3
    s_add_u32 s44, s44, s36
    s_mul_i32 s44, s44, 81920
    s_mul_i32 s45, s37, 5120
    s_add_u32 s67, s44, s45
    s_mov_b32 s68, 5
    s_cmp_lt_u32 s38, 4
    s_cbranch_scc1 L_cpe_10
    s_lshl_b32 s67, s67, 1
    s_add_u32 s67, s67, 2621440
    s_cmp_lt_u32 s38, 8
    s_cbranch_scc1 L_cpe_10
    s_add_u32 s67, s67, 5120
    s_branch L_cpe_10
L_cpd_9:
    s_cmp_lt_u32 s38, 14
    s_mov_b32 s47, 8650752
    s_cselect_b32 s47, 7864320, s47
    s_and_b32 s44, s38, 1
    s_mul_i32 s44, s44, 5
    s_add_u32 s44, s44, s36
    s_mul_i32 s44, s44, 67584
    s_lshl_b32 s45, s37, 12
    s_add_u32 s67, s44, s45
    s_add_u32 s67, s67, s47
    s_cmp_lt_u32 s36, 5
    s_cselect_b32 s68, 4, 0
L_cpe_10:
    s_waitcnt vmcnt(18)
    s_cmp_lg_u32 s38, 14
    s_cbranch_scc1 L_nopatch_11
    s_mov_b64 exec, 0xffff
    v_add_u32 v2, 73728, v30
    ds_write_b16 v2, v31
    s_mov_b64 exec, -1
    s_waitcnt lgkmcnt(0)
L_nopatch_11:
    s_barrier
    s_lshl_b32 s61, s69, 7
    s_add_u32 m0, s48, 36864
    s_nop 0
    buffer_load_dwordx4 v20, s[8:11], s61 offen lds
    s_add_u32 m0, s48, 37888
    s_nop 0
    buffer_load_dwordx4 v21, s[8:11], s61 offen lds
    s_add_u32 m0, s48, 38912
    s_nop 0
    buffer_load_dwordx4 v22, s[8:11], s61 offen lds
    s_add_u32 m0, s48, 39936
    s_nop 0
    buffer_load_dwordx4 v23, s[8:11], s61 offen lds
    s_mul_i32 s62, s63, s69
    s_add_u32 m0, s49, 36864
    s_nop 0
    buffer_load_dwordx4 v24, s[12:15], s62 offen lds
    s_add_u32 m0, s49, 37888
    s_nop 0
    buffer_load_dwordx4 v25, s[12:15], s62 offen lds
    s_add_u32 m0, s49, 38912
    s_nop 0
    buffer_load_dwordx4 v26, s[12:15], s62 offen lds
    s_add_u32 m0, s49, 39936
    s_nop 0
    buffer_load_dwordx4 v27, s[12:15], s62 offen lds
    s_add_u32 m0, s49, 40960
    s_nop 0
    buffer_load_dwordx4 v28, s[12:15], s62 offen lds
    s_add_u32 s69, s69, 1
    s_cmp_eq_u32 s69, 10
    s_cselect_b32 s69, 0, s69
    s_lshl_b32 s52, s2, 2
    s_add_u32 s52, s52, s40
    s_cmp_ge_u32 s52, 272
    s_cselect_b32 s56, 1048576000, 0
    s_cselect_b32 s53, 272, 0
    s_sub_u32 s53, s52, s53
    s_and_b32 s54, s53, 15
    s_lshr_b32 s53, s53, 4
    s_lshl_b32 s53, s53, 5
    s_lshl_b32 s54, s54, 6
    v_and_b32 v60, 31, v1
    v_add_u32 v60, s53, v60
    v_lshrrev_b32 v61, 5, v1
    v_lshl_add_u32 v61, v61, 4, s54
    v_mul_u32_u24 v62, v60, v61
    v_and_b32 v62, 2047, v62
    v_cvt_f32_u32 v62, v62
    v_cvt_f32_u32 v63, v60
    s_mov_b32 s55, 973078528
    v_mul_f32 v62, s55, v62
    v_mul_f32 v63, s55, v63
    v_add_f32 v62, s56, v62
    v_add_f32 v64, v63, v63
    s_lshl_b32 s58, s52, 12
    s_add_u32 s58, s58, 16777216
    s_cmp_lt_u32 s52, 544
    s_cselect_b32 s58, s58, 1073741824
    v_lshlrev_b32 v65, 4, v1
    s_waitcnt vmcnt(18)
    s_cmp_lg_u32 s38, 14
    s_cbranch_scc1 L_nopatch_12
    s_mov_b64 exec, 0xffff
    v_add_u32 v2, 110592, v30
    ds_write_b16 v2, v31
    s_mov_b64 exec, -1
    s_waitcnt lgkmcnt(0)
L_nopatch_12:
    s_barrier
    s_lshl_b32 s61, s69, 7
    s_add_u32 m0, s48, 73728
    s_nop 0
    buffer_load_dwordx4 v20, s[8:11], s61 offen lds
    s_add_u32 m0, s48, 74752
    s_nop 0
    buffer_load_dwordx4 v21, s[8:11], s61 offen lds
    s_add_u32 m0, s48, 75776
    s_nop 0
    buffer_load_dwordx4 v22, s[8:11], s61 offen lds
    s_add_u32 m0, s48, 76800
    s_nop 0
    buffer_load_dwordx4 v23, s[8:11], s61 offen lds
    s_mul_i32 s62, s63, s69
    s_add_u32 m0, s49, 73728
    s_nop 0
    buffer_load_dwordx4 v24, s[12:15], s62 offen lds
    s_add_u32 m0, s49, 74752
    s_nop 0
    buffer_load_dwordx4 v25, s[12:15], s62 offen lds
    s_add_u32 m0, s49, 75776
    s_nop 0
    buffer_load_dwordx4 v26, s[12:15], s62 offen lds
    s_add_u32 m0, s49, 76800
    s_nop 0
    buffer_load_dwordx4 v27, s[12:15], s62 offen lds
    s_add_u32 m0, s49, 77824
    s_nop 0
    buffer_load_dwordx4 v28, s[12:15], s62 offen lds
    s_add_u32 s69, s69, 1
    s_cmp_eq_u32 s69, 10
    s_cselect_b32 s69, 0, s69
    v_mov_b32 v74, v62
    v_fract_f32 v74, v74
    v_cos_f32 v66, v74
    v_add_f32 v74, v74, v64
    v_fract_f32 v74, v74
    v_cos_f32 v67, v74
    v_add_f32 v74, v74, v64
    v_fract_f32 v74, v74
    v_cos_f32 v68, v74
    v_add_f32 v74, v74, v64
    v_fract_f32 v74, v74
    v_cos_f32 v69, v74
    v_add_f32 v74, v74, v64
    v_fract_f32 v74, v74
    v_cos_f32 v70, v74
    v_add_f32 v74, v74, v64
    v_fract_f32 v74, v74
    v_cos_f32 v71, v74
    v_add_f32 v74, v74, v64
    v_fract_f32 v74, v74
    v_cos_f32 v72, v74
    v_add_f32 v74, v74, v64
    v_fract_f32 v74, v74
    v_cos_f32 v73, v74
    v_add_f32 v74, v74, v64
    v_cvt_pk_bf16_f32 v40, v66, v67
    v_cvt_pk_bf16_f32 v41, v68, v69
    v_cvt_pk_bf16_f32 v42, v70, v71
    v_cvt_pk_bf16_f32 v43, v72, v73
    buffer_store_dwordx4 v[40:43], v65, s[20:23], s58 offen offset:0 sc1
    s_waitcnt vmcnt(19)
    s_cmp_lg_u32 s38, 14
    s_cbranch_scc1 L_nopatch_13
    s_mov_b64 exec, 0xffff
    v_add_u32 v2, 0, v30
    ds_write_b16 v2, v31
    s_mov_b64 exec, -1
    s_waitcnt lgkmcnt(0)
L_nopatch_13:
    s_barrier
    s_lshl_b32 s61, s69, 7
    s_add_u32 m0, s48, 110592
    s_nop 0
    buffer_load_dwordx4 v20, s[8:11], s61 offen lds
    s_add_u32 m0, s48, 111616
    s_nop 0
    buffer_load_dwordx4 v21, s[8:11], s61 offen lds
    s_add_u32 m0, s48, 112640
    s_nop 0
    buffer_load_dwordx4 v22, s[8:11], s61 offen lds
    s_add_u32 m0, s48, 113664
    s_nop 0
    buffer_load_dwordx4 v23, s[8:11], s61 offen lds
    s_mul_i32 s62, s63, s69
    s_add_u32 m0, s49, 110592
    s_nop 0
    buffer_load_dwordx4 v24, s[12:15], s62 offen lds
    s_add_u32 m0, s49, 111616
    s_nop 0
    buffer_load_dwordx4 v25, s[12:15], s62 offen lds
    s_add_u32 m0, s49, 112640
    s_nop 0
    buffer_load_dwordx4 v26, s[12:15], s62 offen lds
    s_add_u32 m0, s49, 113664
    s_nop 0
    buffer_load_dwordx4 v27, s[12:15], s62 offen lds
    s_add_u32 m0, s49, 114688
    s_nop 0
    buffer_load_dwordx4 v28, s[12:15], s62 offen lds
    s_add_u32 s69, s69, 1
    s_cmp_eq_u32 s69, 10
    s_cselect_b32 s69, 0, s69
    v_add_f32 v74, v62, v63
    v_fract_f32 v74, v74
    v_cos_f32 v66, v74
    v_add_f32 v74, v74, v64
    v_fract_f32 v74, v74
    v_cos_f32 v67, v74
    v_add_f32 v74, v74, v64
    v_fract_f32 v74, v74
    v_cos_f32 v68, v74
    v_add_f32 v74, v74, v64
    v_fract_f32 v74, v74
    v_cos_f32 v69, v74
    v_add_f32 v74, v74, v64
    v_fract_f32 v74, v74
    v_cos_f32 v70, v74
    v_add_f32 v74, v74, v64
    v_fract_f32 v74, v74
    v_cos_f32 v71, v74
    v_add_f32 v74, v74, v64
    v_fract_f32 v74, v74
    v_cos_f32 v72, v74
    v_add_f32 v74, v74, v64
    v_fract_f32 v74, v74
    v_cos_f32 v73, v74
    v_add_f32 v74, v74, v64
    v_cvt_pk_bf16_f32 v44, v66, v67
    v_cvt_pk_bf16_f32 v45, v68, v69
    v_cvt_pk_bf16_f32 v46, v70, v71
    v_cvt_pk_bf16_f32 v47, v72, v73
    buffer_store_dwordx4 v[44:47], v65, s[20:23], s58 offen offset:1024 sc1
    s_waitcnt vmcnt(20)
    s_cmp_lg_u32 s38, 14
    s_cbranch_scc1 L_nopatch_14
    s_mov_b64 exec, 0xffff
    v_add_u32 v2, 36864, v30
    ds_write_b16 v2, v31
    s_mov_b64 exec, -1
    s_waitcnt lgkmcnt(0)
L_nopatch_14:
    s_barrier
    s_lshl_b32 s61, s69, 7
    s_add_u32 m0, s48, 0
    s_nop 0
    buffer_load_dwordx4 v20, s[8:11], s61 offen lds
    s_add_u32 m0, s48, 1024
    s_nop 0
    buffer_load_dwordx4 v21, s[8:11], s61 offen lds
    s_add_u32 m0, s48, 2048
    s_nop 0
    buffer_load_dwordx4 v22, s[8:11], s61 offen lds
    s_add_u32 m0, s48, 3072
    s_nop 0
    buffer_load_dwordx4 v23, s[8:11], s61 offen lds
    s_mul_i32 s62, s63, s69
    s_add_u32 m0, s49, 0
    s_nop 0
    buffer_load_dwordx4 v24, s[12:15], s62 offen lds
    s_add_u32 m0, s49, 1024
    s_nop 0
    buffer_load_dwordx4 v25, s[12:15], s62 offen lds
    s_add_u32 m0, s49, 2048
    s_nop 0
    buffer_load_dwordx4 v26, s[12:15], s62 offen lds
    s_add_u32 m0, s49, 3072
    s_nop 0
    buffer_load_dwordx4 v27, s[12:15], s62 offen lds
    s_add_u32 m0, s49, 4096
    s_nop 0
    buffer_load_dwordx4 v28, s[12:15], s62 offen lds
    s_add_u32 s69, s69, 1
    s_cmp_eq_u32 s69, 10
    s_cselect_b32 s69, 0, s69
    v_mov_b32 v75, 1107296256
    v_fma_f32 v74, v63, v75, v62
    v_fract_f32 v74, v74
    v_cos_f32 v66, v74
    v_add_f32 v74, v74, v64
    v_fract_f32 v74, v74
    v_cos_f32 v67, v74
    v_add_f32 v74, v74, v64
    v_fract_f32 v74, v74
    v_cos_f32 v68, v74
    v_add_f32 v74, v74, v64
    v_fract_f32 v74, v74
    v_cos_f32 v69, v74
    v_add_f32 v74, v74, v64
    v_fract_f32 v74, v74
    v_cos_f32 v70, v74
    v_add_f32 v74, v74, v64
    v_fract_f32 v74, v74
    v_cos_f32 v71, v74
    v_add_f32 v74, v74, v64
    v_fract_f32 v74, v74
    v_cos_f32 v72, v74
    v_add_f32 v74, v74, v64
    v_fract_f32 v74, v74
    v_cos_f32 v73, v74
    v_add_f32 v74, v74, v64
    v_cvt_pk_bf16_f32 v48, v66, v67
    v_cvt_pk_bf16_f32 v49, v68, v69
    v_cvt_pk_bf16_f32 v50, v70, v71
    v_cvt_pk_bf16_f32 v51, v72, v73
    buffer_store_dwordx4 v[48:51], v65, s[20:23], s58 offen offset:2048 sc1
    s_waitcnt vmcnt(21)
    s_cmp_lg_u32 s38, 14
    s_cbranch_scc1 L_nopatch_15
    s_mov_b64 exec, 0xffff
    v_add_u32 v2, 73728, v30
    ds_write_b16 v2, v31
    s_mov_b64 exec, -1
    s_waitcnt lgkmcnt(0)
L_nopatch_15:
    s_barrier
    s_lshl_b32 s61, s69, 7
    s_add_u32 m0, s48, 36864
    s_nop 0
    buffer_load_dwordx4 v20, s[8:11], s61 offen lds
    s_add_u32 m0, s48, 37888
    s_nop 0
    buffer_load_dwordx4 v21, s[8:11], s61 offen lds
    s_add_u32 m0, s48, 38912
    s_nop 0
    buffer_load_dwordx4 v22, s[8:11], s61 offen lds
    s_add_u32 m0, s48, 39936
    s_nop 0
    buffer_load_dwordx4 v23, s[8:11], s61 offen lds
    s_mul_i32 s62, s63, s69
    s_add_u32 m0, s49, 36864
    s_nop 0
    buffer_load_dwordx4 v24, s[12:15], s62 offen lds
    s_add_u32 m0, s49, 37888
    s_nop 0
    buffer_load_dwordx4 v25, s[12:15], s62 offen lds
    s_add_u32 m0, s49, 38912
    s_nop 0
    buffer_load_dwordx4 v26, s[12:15], s62 offen lds
    s_add_u32 m0, s49, 39936
    s_nop 0
    buffer_load_dwordx4 v27, s[12:15], s62 offen lds
    s_add_u32 m0, s49, 40960
    s_nop 0
    buffer_load_dwordx4 v28, s[12:15], s62 offen lds
    s_add_u32 s69, s69, 1
    s_cmp_eq_u32 s69, 10
    s_cselect_b32 s69, 0, s69
    v_mov_b32 v75, 1107558400
    v_fma_f32 v74, v63, v75, v62
    v_fract_f32 v74, v74
    v_cos_f32 v66, v74
    v_add_f32 v74, v74, v64
    v_fract_f32 v74, v74
    v_cos_f32 v67, v74
    v_add_f32 v74, v74, v64
    v_fract_f32 v74, v74
    v_cos_f32 v68, v74
    v_add_f32 v74, v74, v64
    v_fract_f32 v74, v74
    v_cos_f32 v69, v74
    v_add_f32 v74, v74, v64
    v_fract_f32 v74, v74
    v_cos_f32 v70, v74
    v_add_f32 v74, v74, v64
    v_fract_f32 v74, v74
    v_cos_f32 v71, v74
    v_add_f32 v74, v74, v64
    v_fract_f32 v74, v74
    v_cos_f32 v72, v74
    v_add_f32 v74, v74, v64
    v_fract_f32 v74, v74
    v_cos_f32 v73, v74
    v_add_f32 v74, v74, v64
    v_cvt_pk_bf16_f32 v52, v66, v67
    v_cvt_pk_bf16_f32 v53, v68, v69
    v_cvt_pk_bf16_f32 v54, v70, v71
    v_cvt_pk_bf16_f32 v55, v72, v73
    buffer_store_dwordx4 v[52:55], v65, s[20:23], s58 offen offset:3072 sc1
    s_waitcnt vmcnt(21)
    s_cmp_lg_u32 s38, 14
    s_cbranch_scc1 L_nopatch_16
    s_mov_b64 exec, 0xffff
    v_add_u32 v2, 110592, v30
    ds_write_b16 v2, v31
    s_mov_b64 exec, -1
    s_waitcnt lgkmcnt(0)
L_nopatch_16:
    s_barrier
    s_waitcnt vmcnt(11)
    s_cmp_lg_u32 s38, 14
    s_cbranch_scc1 L_nopatch_17
    s_mov_b64 exec, 0xffff
    v_add_u32 v2, 0, v30
    ds_write_b16 v2, v31
    s_mov_b64 exec, -1
    s_waitcnt lgkmcnt(0)
L_nopatch_17:
    s_barrier
    s_waitcnt vmcnt(1)
    s_cmp_lg_u32 s38, 14
    s_cbranch_scc1 L_nopatch_18
    s_mov_b64 exec, 0xffff
    v_add_u32 v2, 36864, v30
    ds_write_b16 v2, v31
    s_mov_b64 exec, -1
    s_waitcnt lgkmcnt(0)
L_nopatch_18:
    s_barrier
L_k1_copy:
    s_waitcnt lgkmcnt(0)
    s_barrier
    s_cmp_eq_u32 s68, 0
    s_cbranch_scc1 L_k1_done
    s_mul_i32 s44, s36, s68
    s_lshl_b32 s44, s44, 10
    s_add_u32 s44, s44, 73728
    v_lshlrev_b32 v2, 4, v1
    v_add_u32 v3, s44, v2
    ds_read_b128 v[4:7], v3 offset:0
    ds_read_b128 v[8:11], v3 offset:1024
    ds_read_b128 v[12:15], v3 offset:2048
    ds_read_b128 v[16:19], v3 offset:3072
    ds_read_b128 v[20:23], v3 offset:4096
    s_waitcnt lgkmcnt(4)
    buffer_store_dwordx4 v[4:7], v2, s[20:23], s67 offen offset:0 sc1
    s_waitcnt lgkmcnt(3)
    buffer_store_dwordx4 v[8:11], v2, s[20:23], s67 offen offset:1024 sc1
    s_waitcnt lgkmcnt(2)
    buffer_store_dwordx4 v[12:15], v2, s[20:23], s67 offen offset:2048 sc1
    s_waitcnt lgkmcnt(1)
    buffer_store_dwordx4 v[16:19], v2, s[20:23], s67 offen offset:3072 sc1
    s_cmp_eq_u32 s68, 4
    s_cbranch_scc1 L_k1_done
    s_add_u32 s67, s67, 4096
    s_waitcnt lgkmcnt(0)
    buffer_store_dwordx4 v[20:23], v2, s[20:23], s67 offen sc1
L_k1_done:
    s_endpgm
L_k1_exit:
    s_endpgm
.globl attn_dft2_kernel
.p2align 8
.type attn_dft2_kernel,@function
attn_dft2_kernel:
    s_cmp_ge_u32 s2, 256
    s_cbranch_scc1 L_k2_exit
    s_load_dwordx2 s[4:5], s[0:1], 88
    s_load_dwordx2 s[68:69], s[0:1], 0
    s_load_dwordx2 s[70:71], s[0:1], 16
    s_load_dwordx4 s[72:75], s[0:1], 32
    s_load_dwordx2 s[76:77], s[0:1], 64
    v_and_b32 v1, 63, v0
    v_lshrrev_b32 v2, 6, v0
    s_nop 0
    v_readfirstlane_b32 s52, v2
    s_and_b32 s60, s2, 7
    s_lshl_b32 s60, s60, 2
    s_lshr_b32 s61, s2, 3
    s_and_b32 s61, s61, 3
    s_add_u32 s53, s60, s61
    s_lshr_b32 s54, s2, 5
    s_mul_i32 s60, s53, 81920
    s_mul_i32 s61, s53, 163840
    s_add_u32 s61, s61, 2621440
    s_waitcnt lgkmcnt(0)
    s_add_u32 s8, s4, s60
    s_addc_u32 s9, s5, 0
    s_mov_b32 s10, 81920
    s_mov_b32 s11, 0x00020000
    s_add_u32 s12, s4, s61
    s_addc_u32 s13, s5, 0
    s_mov_b32 s14, 163840
    s_mov_b32 s15, 0x00020000
    s_add_u32 s16, s4, 12189696
    s_addc_u32 s17, s5, 0
    s_mov_b32 s18, 2621440
    s_mov_b32 s19, 0x00020000
    s_add_u32 s40, s4, 16777216
    s_addc_u32 s41, s5, 0
    s_mov_b32 s42, 1114112
    s_mov_b32 s43, 0x00020000
    s_add_u32 s44, s4, 17891328
    s_addc_u32 s45, s5, 0
    s_mov_b32 s46, 1114112
    s_mov_b32 s47, 0x00020000
    s_add_u32 s28, s4, 7864320
    s_addc_u32 s29, s5, 0
    s_mov_b32 s30, 743424
    s_mov_b32 s31, 0x00020000
    s_add_u32 s32, s4, 8650752
    s_addc_u32 s33, s5, 0
    s_mov_b32 s34, 743424
    s_mov_b32 s35, 0x00020000
    s_add_u32 s36, s4, 9437184
    s_addc_u32 s37, s5, 0
    s_mov_b32 s38, 2703352
    s_mov_b32 s39, 0x00020000
    s_cmp_ge_u32 s52, 8
    s_cbranch_scc1 L_k2_helper
    s_lshr_b32 s60, s52, 2
    s_lshl_b32 s61, s54, 1
    s_add_u32 s60, s60, s61
    s_mul_i32 s60, s60, 5120
    s_and_b32 s61, s52, 3
    s_lshl_b32 s62, s61, 10
    s_add_u32 s62, s62, s60
    v_lshlrev_b32 v2, 4, v1
    buffer_load_dwordx4 v[10:13], v2, s[8:11], s62 offen
    s_lshr_b32 s63, s61, 1
    s_lshl_b32 s63, s63, 9
    s_and_b32 s64, s61, 1
    s_lshl_b32 s64, s64, 3
    s_add_u32 s63, s63, s64
    s_add_u32 s63, s63, s60
    s_add_u32 s63, s63, 4096
    v_and_b32 v4, 31, v1
    v_lshlrev_b32 v5, 4, v4
    buffer_load_dwordx2 v[6:7], v5, s[8:11], s63 offen
    v_lshrrev_b32 v8, 5, v1
    v_mad_u32_u24 v3, v8, 20, v4
    v_lshlrev_b32 v3, 4, v3
    v_add_u32 v130, 5120, v3
    v_mov_b32 v129, v2
    v_mov_b32 v9, 0x3f803f80
    v_cmp_eq_u32 vcc, 20, v4
    s_nop 1
    v_cndmask_b32 v9, 0, v9, vcc
    v_mov_b32 v112, v9
    v_mov_b32 v113, v9
    v_mov_b32 v114, v9
    v_mov_b32 v115, v9
    v_mov_b32 v116, v9
    v_mov_b32 v117, v9
    v_mov_b32 v118, v9
    v_mov_b32 v119, v9
    v_mov_b32 v120, v9
    v_mov_b32 v121, v9
    v_mov_b32 v122, v9
    v_mov_b32 v123, v9
    v_mov_b32 v124, v9
    v_mov_b32 v125, v9
    v_mov_b32 v126, v9
    v_mov_b32 v127, v9
    v_cmp_gt_u32 s[58:59], 20, v4
    v_mov_b32 v14, 0
    v_mov_b32 v15, 0
    v_mov_b32 v18, 0
    v_mov_b32 v19, 0
    v_mov_b32 v22, 0
    v_mov_b32 v23, 0
    v_cmp_gt_u32 vcc, 32, v1
    s_waitcnt vmcnt(0)
    v_cndmask_b32 v16, 0, v6, vcc
    v_cndmask_b32 v17, 0, v7, vcc
    v_cndmask_b32 v20, v6, 0, vcc
    v_cndmask_b32 v21, v7, 0, vcc
    s_mov_b32 s56, 196609
    s_mov_b32 s57, 0
    s_bitcmp1_b32 s52, 2
    s_cselect_b32 s79, 6, 3
    s_cbranch_scc0 L_pr_19
    s_setprio 1
L_pr_19:
    s_barrier
    ds_read_b128 v[96:99], v2 offset:0
    ds_read_b128 v[104:107], v2 offset:4096
    s_waitcnt lgkmcnt(0)
    v_mfma_f32_32x32x16_bf16 v[40:55], v[96:99], v[10:13], 0
    v_mfma_f32_32x32x16_bf16 v[40:55], v[104:107], v[16:19], v[40:55]
    s_nop 15
    v_max3_f32 v128, v40, v41, v42
    v_max3_f32 v128, v128, v43, v44
    v_max3_f32 v128, v128, v45, v46
    v_max3_f32 v128, v128, v47, v48
    v_max3_f32 v128, v128, v49, v50
    v_max3_f32 v128, v128, v51, v52
    v_max3_f32 v128, v128, v53, v54
    v_max_f32 v128, v128, v55
    v_mov_b32 v4, v128
    v_mov_b32 v5, v128
    s_nop 1
    v_permlane32_swap_b32 v4, v5
    s_nop 1
    v_max_f32 v128, v4, v5
L_att_run:
    v_mov_b32 v2, v129
    v_mov_b32 v3, v130
    ds_read_b128 v[96:99], v2 offset:0
    ds_read_b128 v[104:107], v2 offset:4096
    ds_read_b128 v[100:103], v2 offset:1024
    s_mov_b64 exec, s[58:59]
    ds_read_b128 v[112:115], v3 offset:0
    ds_read_b128 v[120:123], v3 offset:640
    s_mov_b64 exec, -1
    v_sub_f32 v24, 0, v128
    v_sub_f32 v25, 0, v128
    v_sub_f32 v26, 0, v128
    v_sub_f32 v27, 0, v128
    v_sub_f32 v28, 0, v128
    v_sub_f32 v29, 0, v128
    v_sub_f32 v30, 0, v128
    v_sub_f32 v31, 0, v128
    v_sub_f32 v32, 0, v128
    v_sub_f32 v33, 0, v128
    v_sub_f32 v34, 0, v128
    v_sub_f32 v35, 0, v128
    v_sub_f32 v36, 0, v128
    v_sub_f32 v37, 0, v128
    v_sub_f32 v38, 0, v128
    v_sub_f32 v39, 0, v128
    v_mov_b32 v72, 0
    v_mov_b32 v73, 0
    v_mov_b32 v74, 0
    v_mov_b32 v75, 0
    v_mov_b32 v76, 0
    v_mov_b32 v77, 0
    v_mov_b32 v78, 0
    v_mov_b32 v79, 0
    v_mov_b32 v80, 0
    v_mov_b32 v81, 0
    v_mov_b32 v82, 0
    v_mov_b32 v83, 0
    v_mov_b32 v84, 0
    v_mov_b32 v85, 0
    v_mov_b32 v86, 0
    v_mov_b32 v87, 0
    v_mov_b32 v88, 0
    v_mov_b32 v89, 0
    v_mov_b32 v90, 0
    v_mov_b32 v91, 0
    v_mov_b32 v92, 0
    v_mov_b32 v93, 0
    v_mov_b32 v94, 0
    v_mov_b32 v95, 0
    s_mov_b32 s55, 0
    s_mov_b32 s60, 16
    s_waitcnt lgkmcnt(0)
    v_mfma_f32_32x32x16_bf16 v[40:55], v[96:99], v[10:13], v[24:39]
    v_mfma_f32_32x32x16_bf16 v[40:55], v[104:107], v[16:19], v[40:55]
    s_nop 7
    .p2align 3
L_att_loop:
    s_cmp_lg_u32 s55, s79
    s_cbranch_scc1 L_pr_21
    s_bitcmp1_b32 s52, 2
    s_cbranch_scc1 L_pr_20
    s_setprio 2
    s_branch L_pr_21
L_pr_20:
    s_setprio 0
L_pr_21:
    ds_read_b128 v[96:99], v2 offset:2048
    s_waitcnt lgkmcnt(1)
    v_mfma_f32_32x32x16_bf16 v[72:87], v[124:127], v[92:95], v[72:87]
    s_mov_b64 exec, s[58:59]
    ds_read_b128 v[116:119], v3 offset:1280
    ds_read_b128 v[124:127], v3 offset:1920
    s_mov_b64 exec, -1
    v_exp_f32 v40, v40
    v_exp_f32 v41, v41
    v_exp_f32 v42, v42
    v_exp_f32 v43, v43
    v_cvt_pk_bf16_f32 v88, v40, v41
    v_cvt_pk_bf16_f32 v89, v42, v43
    v_mfma_f32_32x32x16_bf16 v[56:71], v[100:103], v[10:13], v[24:39]
    v_exp_f32 v44, v44
    v_exp_f32 v45, v45
    v_exp_f32 v46, v46
    v_exp_f32 v47, v47
    v_cvt_pk_bf16_f32 v90, v44, v45
    v_cvt_pk_bf16_f32 v91, v46, v47
    v_mfma_f32_32x32x16_bf16 v[56:71], v[104:107], v[14:17], v[56:71]
    v_exp_f32 v48, v48
    v_exp_f32 v49, v49
    v_exp_f32 v50, v50
    v_exp_f32 v51, v51
    v_cvt_pk_bf16_f32 v92, v48, v49
    v_cvt_pk_bf16_f32 v93, v50, v51
    v_mfma_f32_32x32x16_bf16 v[72:87], v[112:115], v[88:91], v[72:87]
    v_exp_f32 v52, v52
    v_exp_f32 v53, v53
    v_exp_f32 v54, v54
    v_exp_f32 v55, v55
    v_cvt_pk_bf16_f32 v94, v52, v53
    v_cvt_pk_bf16_f32 v95, v54, v55
    ds_read_b128 v[100:103], v2 offset:3072
    s_waitcnt lgkmcnt(1)
    v_mfma_f32_32x32x16_bf16 v[72:87], v[120:123], v[92:95], v[72:87]
    s_mov_b64 exec, s[58:59]
    ds_read_b128 v[112:115], v3 offset:2560
    ds_read_b128 v[120:123], v3 offset:3200
    s_mov_b64 exec, -1
    v_exp_f32 v56, v56
    v_exp_f32 v57, v57
    v_exp_f32 v58, v58
    v_exp_f32 v59, v59
    v_cvt_pk_bf16_f32 v88, v56, v57
    v_cvt_pk_bf16_f32 v89, v58, v59
    v_mfma_f32_32x32x16_bf16 v[40:55], v[96:99], v[10:13], v[24:39]
    v_exp_f32 v60, v60
    v_exp_f32 v61, v61
    v_exp_f32 v62, v62
    v_exp_f32 v63, v63
    v_cvt_pk_bf16_f32 v90, v60, v61
    v_cvt_pk_bf16_f32 v91, v62, v63
    v_mfma_f32_32x32x16_bf16 v[40:55], v[104:107], v[20:23], v[40:55]
    v_exp_f32 v64, v64
    v_exp_f32 v65, v65
    v_exp_f32 v66, v66
    v_exp_f32 v67, v67
    v_cvt_pk_bf16_f32 v92, v64, v65
    v_cvt_pk_bf16_f32 v93, v66, v67
    v_mfma_f32_32x32x16_bf16 v[72:87], v[116:119], v[88:91], v[72:87]
    v_exp_f32 v68, v68
    v_exp_f32 v69, v69
    v_exp_f32 v70, v70
    v_exp_f32 v71, v71
    v_cvt_pk_bf16_f32 v94, v68, v69
    v_cvt_pk_bf16_f32 v95, v70, v71
    s_bitcmp1_b32 s56, s55
    s_cbranch_scc0 L_nobar_22
    s_barrier
L_nobar_22:
    ds_read_b128 v[96:99], v2 offset:10240
    ds_read_b128 v[108:111], v2 offset:14336
    s_waitcnt lgkmcnt(2)
    v_mfma_f32_32x32x16_bf16 v[72:87], v[124:127], v[92:95], v[72:87]
    s_mov_b64 exec, s[58:59]
    ds_read_b128 v[116:119], v3 offset:3840
    ds_read_b128 v[124:127], v3 offset:4480
    s_mov_b64 exec, -1
    v_exp_f32 v40, v40
    v_exp_f32 v41, v41
    v_exp_f32 v42, v42
    v_exp_f32 v43, v43
    v_cvt_pk_bf16_f32 v88, v40, v41
    v_cvt_pk_bf16_f32 v89, v42, v43
    v_mfma_f32_32x32x16_bf16 v[56:71], v[100:103], v[10:13], v[24:39]
    v_exp_f32 v44, v44
    v_exp_f32 v45, v45
    v_exp_f32 v46, v46
    v_exp_f32 v47, v47
    v_cvt_pk_bf16_f32 v90, v44, v45
    v_cvt_pk_bf16_f32 v91, v46, v47
    v_mfma_f32_32x32x16_bf16 v[56:71], v[104:107], v[18:21], v[56:71]
    v_exp_f32 v48, v48
    v_exp_f32 v49, v49
    v_exp_f32 v50, v50
    v_exp_f32 v51, v51
    v_cvt_pk_bf16_f32 v92, v48, v49
    v_cvt_pk_bf16_f32 v93, v50, v51
    v_mfma_f32_32x32x16_bf16 v[72:87], v[112:115], v[88:91], v[72:87]
    v_exp_f32 v52, v52
    v_exp_f32 v53, v53
    v_exp_f32 v54, v54
    v_exp_f32 v55, v55
    v_cvt_pk_bf16_f32 v94, v52, v53
    v_cvt_pk_bf16_f32 v95, v54, v55
    ds_read_b128 v[100:103], v2 offset:11264
    s_waitcnt lgkmcnt(1)
    v_mfma_f32_32x32x16_bf16 v[72:87], v[120:123], v[92:95], v[72:87]
    s_mov_b64 exec, s[58:59]
    ds_read_b128 v[112:115], v3 offset:10240
    ds_read_b128 v[120:123], v3 offset:10880
    s_mov_b64 exec, -1
    v_exp_f32 v56, v56
    v_exp_f32 v57, v57
    v_exp_f32 v58, v58
    v_exp_f32 v59, v59
    v_cvt_pk_bf16_f32 v88, v56, v57
    v_cvt_pk_bf16_f32 v89, v58, v59
    v_mfma_f32_32x32x16_bf16 v[40:55], v[96:99], v[10:13], v[24:39]
    v_exp_f32 v60, v60
    v_exp_f32 v61, v61
    v_exp_f32 v62, v62
    v_exp_f32 v63, v63
    v_cvt_pk_bf16_f32 v90, v60, v61
    v_cvt_pk_bf16_f32 v91, v62, v63
    v_mfma_f32_32x32x16_bf16 v[40:55], v[108:111], v[16:19], v[40:55]
    v_exp_f32 v64, v64
    v_exp_f32 v65, v65
    v_exp_f32 v66, v66
    v_exp_f32 v67, v67
    v_cvt_pk_bf16_f32 v92, v64, v65
    v_cvt_pk_bf16_f32 v93, v66, v67
    v_mfma_f32_32x32x16_bf16 v[72:87], v[116:119], v[88:91], v[72:87]
    v_exp_f32 v68, v68
    v_exp_f32 v69, v69
    v_exp_f32 v70, v70
    v_exp_f32 v71, v71
    v_cvt_pk_bf16_f32 v94, v68, v69
    v_cvt_pk_bf16_f32 v95, v70, v71
    ds_read_b128 v[96:99], v2 offset:12288
    s_waitcnt lgkmcnt(1)
    v_mfma_f32_32x32x16_bf16 v[72:87], v[124:127], v[92:95], v[72:87]
    s_mov_b64 exec, s[58:59]
    ds_read_b128 v[116:119], v3 offset:11520
    ds_read_b128 v[124:127], v3 offset:12160
    s_mov_b64 exec, -1
    v_exp_f32 v40, v40
    v_exp_f32 v41, v41
    v_exp_f32 v42, v42
    v_exp_f32 v43, v43
    v_cvt_pk_bf16_f32 v88, v40, v41
    v_cvt_pk_bf16_f32 v89, v42, v43
    v_mfma_f32_32x32x16_bf16 v[56:71], v[100:103], v[10:13], v[24:39]
    v_exp_f32 v44, v44
    v_exp_f32 v45, v45
    v_exp_f32 v46, v46
    v_exp_f32 v47, v47
    v_cvt_pk_bf16_f32 v90, v44, v45
    v_cvt_pk_bf16_f32 v91, v46, v47
    v_mfma_f32_32x32x16_bf16 v[56:71], v[108:111], v[14:17], v[56:71]
    v_exp_f32 v48, v48
    v_exp_f32 v49, v49
    v_exp_f32 v50, v50
    v_exp_f32 v51, v51
    v_cvt_pk_bf16_f32 v92, v48, v49
    v_cvt_pk_bf16_f32 v93, v50, v51
    v_mfma_f32_32x32x16_bf16 v[72:87], v[112:115], v[88:91], v[72:87]
    v_exp_f32 v52, v52
    v_exp_f32 v53, v53
    v_exp_f32 v54, v54
    v_exp_f32 v55, v55
    v_cvt_pk_bf16_f32 v94, v52, v53
    v_cvt_pk_bf16_f32 v95, v54, v55
    ds_read_b128 v[100:103], v2 offset:13312
    s_waitcnt lgkmcnt(1)
    v_mfma_f32_32x32x16_bf16 v[72:87], v[120:123], v[92:95], v[72:87]
    s_mov_b64 exec, s[58:59]
    ds_read_b128 v[112:115], v3 offset:12800
    ds_read_b128 v[120:123], v3 offset:13440
    s_mov_b64 exec, -1
    v_exp_f32 v56, v56
    v_exp_f32 v57, v57
    v_exp_f32 v58, v58
    v_exp_f32 v59, v59
    v_cvt_pk_bf16_f32 v88, v56, v57
    v_cvt_pk_bf16_f32 v89, v58, v59
    v_mfma_f32_32x32x16_bf16 v[40:55], v[96:99], v[10:13], v[24:39]
    v_exp_f32 v60, v60
    v_exp_f32 v61, v61
    v_exp_f32 v62, v62
    v_exp_f32 v63, v63
    v_cvt_pk_bf16_f32 v90, v60, v61
    v_cvt_pk_bf16_f32 v91, v62, v63
    v_mfma_f32_32x32x16_bf16 v[40:55], v[108:111], v[20:23], v[40:55]
    v_exp_f32 v64, v64
    v_exp_f32 v65, v65
    v_exp_f32 v66, v66
    v_exp_f32 v67, v67
    v_cvt_pk_bf16_f32 v92, v64, v65
    v_cvt_pk_bf16_f32 v93, v66, v67
    v_mfma_f32_32x32x16_bf16 v[72:87], v[116:119], v[88:91], v[72:87]
    v_exp_f32 v68, v68
    v_exp_f32 v69, v69
    v_exp_f32 v70, v70
    v_exp_f32 v71, v71
    v_cvt_pk_bf16_f32 v94, v68, v69
    v_cvt_pk_bf16_f32 v95, v70, v71
    s_bitcmp1_b32 s56, s60
    s_cbranch_scc0 L_nobar_23
    s_barrier
L_nobar_23:
    ds_read_b128 v[96:99], v2 offset:20480
    ds_read_b128 v[104:107], v2 offset:24576
    s_waitcnt lgkmcnt(2)
    v_mfma_f32_32x32x16_bf16 v[72:87], v[124:127], v[92:95], v[72:87]
    s_mov_b64 exec, s[58:59]
    ds_read_b128 v[116:119], v3 offset:14080
    ds_read_b128 v[124:127], v3 offset:14720
    s_mov_b64 exec, -1
    v_exp_f32 v40, v40
    v_exp_f32 v41, v41
    v_exp_f32 v42, v42
    v_exp_f32 v43, v43
    v_cvt_pk_bf16_f32 v88, v40, v41
    v_cvt_pk_bf16_f32 v89, v42, v43
    v_mfma_f32_32x32x16_bf16 v[56:71], v[100:103], v[10:13], v[24:39]
    v_exp_f32 v44, v44
    v_exp_f32 v45, v45
    v_exp_f32 v46, v46
    v_exp_f32 v47, v47
    v_cvt_pk_bf16_f32 v90, v44, v45
    v_cvt_pk_bf16_f32 v91, v46, v47
    v_mfma_f32_32x32x16_bf16 v[56:71], v[108:111], v[18:21], v[56:71]
    v_exp_f32 v48, v48
    v_exp_f32 v49, v49
    v_exp_f32 v50, v50
    v_exp_f32 v51, v51
    v_cvt_pk_bf16_f32 v92, v48, v49
    v_cvt_pk_bf16_f32 v93, v50, v51
    v_mfma_f32_32x32x16_bf16 v[72:87], v[112:115], v[88:91], v[72:87]
    v_exp_f32 v52, v52
    v_exp_f32 v53, v53
    v_exp_f32 v54, v54
    v_exp_f32 v55, v55
    v_cvt_pk_bf16_f32 v94, v52, v53
    v_cvt_pk_bf16_f32 v95, v54, v55
    ds_read_b128 v[100:103], v2 offset:21504
    s_waitcnt lgkmcnt(1)
    v_mfma_f32_32x32x16_bf16 v[72:87], v[120:123], v[92:95], v[72:87]
    s_mov_b64 exec, s[58:59]
    ds_read_b128 v[112:115], v3 offset:20480
    ds_read_b128 v[120:123], v3 offset:21120
    s_mov_b64 exec, -1
    v_exp_f32 v56, v56
    v_exp_f32 v57, v57
    v_exp_f32 v58, v58
    v_exp_f32 v59, v59
    v_cvt_pk_bf16_f32 v88, v56, v57
    v_cvt_pk_bf16_f32 v89, v58, v59
    v_mfma_f32_32x32x16_bf16 v[40:55], v[96:99], v[10:13], v[24:39]
    v_exp_f32 v60, v60
    v_exp_f32 v61, v61
    v_exp_f32 v62, v62
    v_exp_f32 v63, v63
    v_cvt_pk_bf16_f32 v90, v60, v61
    v_cvt_pk_bf16_f32 v91, v62, v63
    v_mfma_f32_32x32x16_bf16 v[40:55], v[104:107], v[16:19], v[40:55]
    v_exp_f32 v64, v64
    v_exp_f32 v65, v65
    v_exp_f32 v66, v66
    v_exp_f32 v67, v67
    v_cvt_pk_bf16_f32 v92, v64, v65
    v_cvt_pk_bf16_f32 v93, v66, v67
    v_mfma_f32_32x32x16_bf16 v[72:87], v[116:119], v[88:91], v[72:87]
    v_exp_f32 v68, v68
    v_exp_f32 v69, v69
    v_exp_f32 v70, v70
    v_exp_f32 v71, v71
    v_cvt_pk_bf16_f32 v94, v68, v69
    v_cvt_pk_bf16_f32 v95, v70, v71
    v_add_u32 v2, 20480, v2
    v_add_u32 v3, 20480, v3
    s_add_u32 s55, s55, 1
    s_add_u32 s60, s60, 1
    s_cmp_lt_u32 s55, 8
    s_cbranch_scc1 L_att_loop
    s_waitcnt lgkmcnt(0)
    v_mfma_f32_32x32x16_bf16 v[72:87], v[124:127], v[92:95], v[72:87]
    s_nop 15
    s_nop 3
    v_add_f32 v4, |v72|, |v73|
    v_add_f32 v4, v4, |v74|
    v_add_f32 v4, v4, |v75|
    v_add_f32 v4, v4, |v76|
    v_add_f32 v4, v4, |v77|
    v_add_f32 v4, v4, |v78|
    v_add_f32 v4, v4, |v79|
    v_add_f32 v4, v4, |v80|
    v_add_f32 v4, v4, |v81|
    v_add_f32 v4, v4, |v82|
    v_add_f32 v4, v4, |v83|
    s_mov_b32 s61, 0x7b800000
    v_cmp_gt_f32 vcc, s61, v4
    s_nop 3
    s_cmp_eq_u64 vcc, exec
    s_cbranch_scc1 L_att_epi
    s_cmp_lg_u32 s57, 0
    s_cbranch_scc1 L_att_epi
    s_mov_b32 s57, 1
    s_mov_b32 s56, 0
    v_mov_b32 v2, v129
    v_mov_b32 v128, 0xff800000
    s_mov_b32 s55, 0
L_att_fbmax:
    ds_read_b128 v[104:107], v2 offset:4096
    ds_read_b128 v[96:99], v2 offset:0
    s_waitcnt lgkmcnt(0)
    v_mfma_f32_32x32x16_bf16 v[40:55], v[96:99], v[10:13], 0
    v_mfma_f32_32x32x16_bf16 v[40:55], v[104:107], v[16:19], v[40:55]
    s_nop 15
    s_nop 3
    v_max3_f32 v128, v128, v40, v41
    v_max3_f32 v128, v128, v42, v43
    v_max3_f32 v128, v128, v44, v45
    v_max3_f32 v128, v128, v46, v47
    v_max3_f32 v128, v128, v48, v49
    v_max3_f32 v128, v128, v50, v51
    v_max3_f32 v128, v128, v52, v53
    v_max3_f32 v128, v128, v54, v55
    ds_read_b128 v[96:99], v2 offset:1024
    s_waitcnt lgkmcnt(0)
    v_mfma_f32_32x32x16_bf16 v[40:55], v[96:99], v[10:13], 0
    v_mfma_f32_32x32x16_bf16 v[40:55], v[104:107], v[14:17], v[40:55]
    s_nop 15
    s_nop 3
    v_max3_f32 v128, v128, v40, v41
    v_max3_f32 v128, v128, v42, v43
    v_max3_f32 v128, v128, v44, v45
    v_max3_f32 v128, v128, v46, v47
    v_max3_f32 v128, v128, v48, v49
    v_max3_f32 v128, v128, v50, v51
    v_max3_f32 v128, v128, v52, v53
    v_max3_f32 v128, v128, v54, v55
    ds_read_b128 v[96:99], v2 offset:2048
    s_waitcnt lgkmcnt(0)
    v_mfma_f32_32x32x16_bf16 v[40:55], v[96:99], v[10:13], 0
    v_mfma_f32_32x32x16_bf16 v[40:55], v[104:107], v[20:23], v[40:55]
    s_nop 15
    s_nop 3
    v_max3_f32 v128, v128, v40, v41
    v_max3_f32 v128, v128, v42, v43
    v_max3_f32 v128, v128, v44, v45
    v_max3_f32 v128, v128, v46, v47
    v_max3_f32 v128, v128, v48, v49
    v_max3_f32 v128, v128, v50, v51
    v_max3_f32 v128, v128, v52, v53
    v_max3_f32 v128, v128, v54, v55
    ds_read_b128 v[96:99], v2 offset:3072
    s_waitcnt lgkmcnt(0)
    v_mfma_f32_32x32x16_bf16 v[40:55], v[96:99], v[10:13], 0
    v_mfma_f32_32x32x16_bf16 v[40:55], v[104:107], v[18:21], v[40:55]
    s_nop 15
    s_nop 3
    v_max3_f32 v128, v128, v40, v41
    v_max3_f32 v128, v128, v42, v43
    v_max3_f32 v128, v128, v44, v45
    v_max3_f32 v128, v128, v46, v47
    v_max3_f32 v128, v128, v48, v49
    v_max3_f32 v128, v128, v50, v51
    v_max3_f32 v128, v128, v52, v53
    v_max3_f32 v128, v128, v54, v55
    v_add_u32 v2, 10240, v2
    s_add_u32 s55, s55, 1
    s_cmp_lt_u32 s55, 16
    s_cbranch_scc1 L_att_fbmax
    v_mov_b32 v4, v128
    v_mov_b32 v5, v128
    s_nop 1
    v_permlane32_swap_b32 v4, v5
    s_nop 1
    v_max_f32 v128, v4, v5
    s_branch L_att_run
L_att_epi:
    v_mov_b32 v4, v80
    v_mov_b32 v5, v80
    s_nop 1
    v_permlane32_swap_b32 v4, v5
    s_nop 1
    v_rcp_f32 v5, v5
    s_lshr_b32 s60, s52, 2
    s_lshl_b32 s61, s54, 1
    s_add_u32 s60, s60, s61
    s_lshl_b32 s60, s60, 6
    s_and_b32 s61, s52, 1
    s_lshl_b32 s61, s61, 5
    s_add_u32 s60, s60, s61
    v_and_b32 v6, 31, v1
    v_add_u32 v6, s60, v6
    s_bitcmp1_b32 s52, 1
    s_cbranch_scc0 L_att_direct
    v_sub_u32 v7, 2048, v6
    v_cmp_eq_u32 vcc, 0, v6
    v_mov_b32 v6, 1024
    s_nop 0
    v_cndmask_b32 v6, v7, v6, vcc
L_att_direct:
    v_lshrrev_b32 v7, 4, v6
    v_mul_u32_u24 v7, 20480, v7
    v_and_b32 v6, 15, v6
    v_lshl_add_u32 v6, v6, 4, v7
    s_mul_i32 s63, s53, 5
    v_lshrrev_b32 v7, 5, v1
    v_add_u32 v7, s63, v7
    v_lshrrev_b32 v4, 1, v7
    v_lshl_add_u32 v6, v4, 8, v6
    v_and_b32 v7, 1, v7
    v_lshl_add_u32 v6, v7, 3, v6
    v_mul_f32 v72, v72, v5
    v_mul_f32 v73, v73, v5
    v_mul_f32 v74, v74, v5
    v_mul_f32 v75, v75, v5
    v_mul_f32 v76, v76, v5
    v_mul_f32 v77, v77, v5
    v_mul_f32 v78, v78, v5
    v_mul_f32 v79, v79, v5
    v_mul_f32 v80, v80, v5
    v_mul_f32 v81, v81, v5
    v_mul_f32 v82, v82, v5
    v_mul_f32 v83, v83, v5
    v_cvt_pk_bf16_f32 v88, v72, v73
    v_cvt_pk_bf16_f32 v89, v74, v75
    v_cvt_pk_bf16_f32 v90, v76, v77
    v_cvt_pk_bf16_f32 v91, v78, v79
    v_cvt_pk_bf16_f32 v92, v80, v81
    v_cvt_pk_bf16_f32 v93, v82, v83
    buffer_store_dwordx2 v[88:89], v6, s[16:19], 0 offen
    buffer_store_dwordx2 v[90:91], v6, s[16:19], 0 offen offset:256
    s_mov_b64 exec, 0xffffffff
    buffer_store_dwordx2 v[92:93], v6, s[16:19], 0 offen offset:512
    s_mov_b64 exec, -1
    s_endpgm
L_k2_helper:
    s_sub_u32 s60, s52, 8
    s_lshl_b32 s60, s60, 10
    v_lshlrev_b32 v2, 4, v1
    s_mov_b32 m0, s60
    s_add_u32 s61, s60, 4096
    buffer_load_dwordx4 v2, s[12:15], s60 offen lds
    s_mov_b32 m0, s61
    s_add_u32 s60, s61, 4096
    buffer_load_dwordx4 v2, s[12:15], s61 offen lds
    s_mov_b32 m0, s60
    s_add_u32 s61, s60, 4096
    buffer_load_dwordx4 v2, s[12:15], s60 offen lds
    s_mov_b32 m0, s61
    s_add_u32 s60, s61, 4096
    buffer_load_dwordx4 v2, s[12:15], s61 offen lds
    s_mov_b32 m0, s60
    s_add_u32 s61, s60, 4096
    buffer_load_dwordx4 v2, s[12:15], s60 offen lds
    s_waitcnt vmcnt(2)
    s_barrier
    s_mov_b32 m0, s61
    s_add_u32 s60, s61, 4096
    buffer_load_dwordx4 v2, s[12:15], s61 offen lds
    s_mov_b32 m0, s60
    s_add_u32 s61, s60, 4096
    buffer_load_dwordx4 v2, s[12:15], s60 offen lds
    s_waitcnt vmcnt(2)
    s_barrier
    s_mov_b32 m0, s61
    s_add_u32 s60, s61, 4096
    buffer_load_dwordx4 v2, s[12:15], s61 offen lds
    s_mov_b32 m0, s60
    s_add_u32 s61, s60, 4096
    buffer_load_dwordx4 v2, s[12:15], s60 offen lds
    s_mov_b32 m0, s61
    s_add_u32 s60, s61, 4096
    buffer_load_dwordx4 v2, s[12:15], s61 offen lds
    s_mov_b32 m0, s60
    s_add_u32 s61, s60, 4096
    buffer_load_dwordx4 v2, s[12:15], s60 offen lds
    s_mov_b32 m0, s61
    s_add_u32 s60, s61, 4096
    buffer_load_dwordx4 v2, s[12:15], s61 offen lds
    s_mov_b32 m0, s60
    s_add_u32 s61, s60, 4096
    buffer_load_dwordx4 v2, s[12:15], s60 offen lds
    s_mov_b32 m0, s61
    s_add_u32 s60, s61, 4096
    buffer_load_dwordx4 v2, s[12:15], s61 offen lds
    s_mov_b32 m0, s60
    s_add_u32 s61, s60, 4096
    buffer_load_dwordx4 v2, s[12:15], s60 offen lds
    s_waitcnt vmcnt(2)
    s_barrier
    s_mov_b32 m0, s61
    s_add_u32 s60, s61, 4096
    buffer_load_dwordx4 v2, s[12:15], s61 offen lds
    s_mov_b32 m0, s60
    s_add_u32 s61, s60, 4096
    buffer_load_dwordx4 v2, s[12:15], s60 offen lds
    s_mov_b32 m0, s61
    s_add_u32 s60, s61, 4096
    buffer_load_dwordx4 v2, s[12:15], s61 offen lds
    s_mov_b32 m0, s60
    s_add_u32 s61, s60, 4096
    buffer_load_dwordx4 v2, s[12:15], s60 offen lds
    s_mov_b32 m0, s61
    s_add_u32 s60, s61, 4096
    buffer_load_dwordx4 v2, s[12:15], s61 offen lds
    s_mov_b32 m0, s60
    s_add_u32 s61, s60, 4096
    buffer_load_dwordx4 v2, s[12:15], s60 offen lds
    s_mov_b32 m0, s61
    s_add_u32 s60, s61, 4096
    buffer_load_dwordx4 v2, s[12:15], s61 offen lds
    s_mov_b32 m0, s60
    s_add_u32 s61, s60, 4096
    buffer_load_dwordx4 v2, s[12:15], s60 offen lds
    s_mov_b32 m0, s61
    s_add_u32 s60, s61, 4096
    buffer_load_dwordx4 v2, s[12:15], s61 offen lds
    s_mov_b32 m0, s60
    s_add_u32 s61, s60, 4096
    buffer_load_dwordx4 v2, s[12:15], s60 offen lds
    s_mov_b32 m0, s61
    s_add_u32 s60, s61, 4096
    buffer_load_dwordx4 v2, s[12:15], s61 offen lds
    s_mov_b32 m0, s60
    s_add_u32 s61, s60, 4096
    buffer_load_dwordx4 v2, s[12:15], s60 offen lds
    s_mov_b32 m0, s61
    s_add_u32 s60, s61, 4096
    buffer_load_dwordx4 v2, s[12:15], s61 offen lds
    s_mov_b32 m0, s60
    s_add_u32 s61, s60, 4096
    buffer_load_dwordx4 v2, s[12:15], s60 offen lds
    s_mov_b32 m0, s61
    s_add_u32 s60, s61, 4096
    buffer_load_dwordx4 v2, s[12:15], s61 offen lds
    s_mov_b32 m0, s60
    s_add_u32 s61, s60, 4096
    buffer_load_dwordx4 v2, s[12:15], s60 offen lds
    s_mov_b32 m0, s61
    s_add_u32 s60, s61, 4096
    buffer_load_dwordx4 v2, s[12:15], s61 offen lds
    s_mov_b32 m0, s60
    s_add_u32 s61, s60, 4096
    buffer_load_dwordx4 v2, s[12:15], s60 offen lds
    s_mov_b32 m0, s61
    s_add_u32 s60, s61, 4096
    buffer_load_dwordx4 v2, s[12:15], s61 offen lds
    s_mov_b32 m0, s60
    s_add_u32 s61, s60, 4096
    buffer_load_dwordx4 v2, s[12:15], s60 offen lds
    s_mov_b32 m0, s61
    s_add_u32 s60, s61, 4096
    buffer_load_dwordx4 v2, s[12:15], s61 offen lds
    s_mov_b32 m0, s60
    s_add_u32 s61, s60, 4096
    buffer_load_dwordx4 v2, s[12:15], s60 offen lds
    s_mov_b32 m0, s61
    s_add_u32 s60, s61, 4096
    buffer_load_dwordx4 v2, s[12:15], s61 offen lds
    s_mov_b32 m0, s60
    s_add_u32 s61, s60, 4096
    buffer_load_dwordx4 v2, s[12:15], s60 offen lds
    s_mov_b32 m0, s61
    s_add_u32 s60, s61, 4096
    buffer_load_dwordx4 v2, s[12:15], s61 offen lds
    s_waitcnt vmcnt(0)
    s_barrier
    s_cmp_eq_u32 s52, 10
    s_cbranch_scc1 L_k2_gate
    s_cmp_eq_u32 s52, 11
    s_cbranch_scc1 L_k2_wopack
    s_lshr_b32 s64, s2, 3
    s_and_b32 s61, s2, 7
    s_cmp_ge_u32 s64, 11
    s_cselect_b32 s60, 8, 0
    s_cselect_b32 s63, 11, 0
    s_add_u32 s62, s61, s60
    s_sub_u32 s63, s64, s63
    s_cmp_lt_u32 s64, 22
    s_cbranch_scc1 L_dft_go
    s_sub_u32 s63, s64, 22
    s_lshl_b32 s63, s63, 3
    s_add_u32 s63, s63, s61
    s_mov_b32 s62, 16
    s_cmp_ge_u32 s63, 11
    s_cbranch_scc1 L_k2_exit
L_dft_go:
    s_cmp_eq_u32 s52, 8
    s_cbranch_scc1 L_dft_isP
    s_mov_b32 s40, s44
    s_mov_b32 s41, s45
    s_mov_b32 s28, s32
    s_mov_b32 s29, s33
    s_add_u32 s36, s36, 8
    s_addc_u32 s37, s37, 0
L_dft_isP:
    v_and_b32 v6, 31, v1
    v_lshrrev_b32 v5, 5, v1
    s_lshl_b32 s60, s62, 5
    s_lshl_b32 s61, s63, 5
    v_add_u32 v4, s61, v6
    s_mul_i32 s67, s63, 67584
    v_lshlrev_b32 v3, 4, v1
    s_lshl_b32 s65, s62, 16
    v_lshlrev_b32 v7, 4, v6
    s_add_u32 s66, s67, 65536
    buffer_load_ushort v7, v7, s[28:31], s66 offen
    s_add_u32 s66, s67, 0
    s_add_u32 s64, s65, 0
    buffer_load_dwordx4 v[40:43], v3, s[40:43], s64 offen offset:0
    buffer_load_dwordx4 v[44:47], v3, s[28:31], s66 offen offset:0
    buffer_load_dwordx4 v[48:51], v3, s[40:43], s64 offen offset:1024
    buffer_load_dwordx4 v[52:55], v3, s[28:31], s66 offen offset:1024
    buffer_load_dwordx4 v[56:59], v3, s[40:43], s64 offen offset:2048
    buffer_load_dwordx4 v[60:63], v3, s[28:31], s66 offen offset:2048
    buffer_load_dwordx4 v[64:67], v3, s[40:43], s64 offen offset:3072
    buffer_load_dwordx4 v[68:71], v3, s[28:31], s66 offen offset:3072
    s_add_u32 s66, s67, 4096
    s_add_u32 s64, s65, 4096
    buffer_load_dwordx4 v[72:75], v3, s[40:43], s64 offen offset:0
    buffer_load_dwordx4 v[76:79], v3, s[28:31], s66 offen offset:0
    buffer_load_dwordx4 v[80:83], v3, s[40:43], s64 offen offset:1024
    buffer_load_dwordx4 v[84:87], v3, s[28:31], s66 offen offset:1024
    buffer_load_dwordx4 v[88:91], v3, s[40:43], s64 offen offset:2048
    buffer_load_dwordx4 v[92:95], v3, s[28:31], s66 offen offset:2048
    buffer_load_dwordx4 v[96:99], v3, s[40:43], s64 offen offset:3072
    buffer_load_dwordx4 v[100:103], v3, s[28:31], s66 offen offset:3072
    s_add_u32 s66, s67, 8192
    s_add_u32 s64, s65, 8192
    buffer_load_dwordx4 v[104:107], v3, s[40:43], s64 offen offset:0
    buffer_load_dwordx4 v[108:111], v3, s[28:31], s66 offen offset:0
    buffer_load_dwordx4 v[112:115], v3, s[40:43], s64 offen offset:1024
    buffer_load_dwordx4 v[116:119], v3, s[28:31], s66 offen offset:1024
    buffer_load_dwordx4 v[120:123], v3, s[40:43], s64 offen offset:2048
    buffer_load_dwordx4 v[124:127], v3, s[28:31], s66 offen offset:2048
    buffer_load_dwordx4 v[128:131], v3, s[40:43], s64 offen offset:3072
    buffer_load_dwordx4 v[132:135], v3, s[28:31], s66 offen offset:3072
    s_add_u32 s66, s67, 12288
    s_add_u32 s64, s65, 12288
    buffer_load_dwordx4 v[136:139], v3, s[40:43], s64 offen offset:0
    buffer_load_dwordx4 v[140:143], v3, s[28:31], s66 offen offset:0
    buffer_load_dwordx4 v[144:147], v3, s[40:43], s64 offen offset:1024
    buffer_load_dwordx4 v[148:151], v3, s[28:31], s66 offen offset:1024
    s_waitcnt vmcnt(26)
    v_mfma_f32_32x32x16_bf16 v[8:23], v[40:43], v[44:47], 0
    buffer_load_dwordx4 v[40:43], v3, s[40:43], s64 offen offset:2048
    buffer_load_dwordx4 v[44:47], v3, s[28:31], s66 offen offset:2048
    s_waitcnt vmcnt(26)
    v_mfma_f32_32x32x16_bf16 v[24:39], v[48:51], v[52:55], 0
    buffer_load_dwordx4 v[48:51], v3, s[40:43], s64 offen offset:3072
    buffer_load_dwordx4 v[52:55], v3, s[28:31], s66 offen offset:3072
    s_waitcnt vmcnt(26)
    v_mfma_f32_32x32x16_bf16 v[8:23], v[56:59], v[60:63], v[8:23]
    s_add_u32 s66, s67, 16384
    s_add_u32 s64, s65, 16384
    buffer_load_dwordx4 v[56:59], v3, s[40:43], s64 offen offset:0
    buffer_load_dwordx4 v[60:63], v3, s[28:31], s66 offen offset:0
    s_waitcnt vmcnt(26)
    v_mfma_f32_32x32x16_bf16 v[24:39], v[64:67], v[68:71], v[24:39]
    buffer_load_dwordx4 v[64:67], v3, s[40:43], s64 offen offset:1024
    buffer_load_dwordx4 v[68:71], v3, s[28:31], s66 offen offset:1024
    s_waitcnt vmcnt(26)
    v_mfma_f32_32x32x16_bf16 v[8:23], v[72:75], v[76:79], v[8:23]
    buffer_load_dwordx4 v[72:75], v3, s[40:43], s64 offen offset:2048
    buffer_load_dwordx4 v[76:79], v3, s[28:31], s66 offen offset:2048
    s_waitcnt vmcnt(26)
    v_mfma_f32_32x32x16_bf16 v[24:39], v[80:83], v[84:87], v[24:39]
    buffer_load_dwordx4 v[80:83], v3, s[40:43], s64 offen offset:3072
    buffer_load_dwordx4 v[84:87], v3, s[28:31], s66 offen offset:3072
    s_waitcnt vmcnt(26)
    v_mfma_f32_32x32x16_bf16 v[8:23], v[88:91], v[92:95], v[8:23]
    s_add_u32 s66, s67, 20480
    s_add_u32 s64, s65, 20480
    buffer_load_dwordx4 v[88:91], v3, s[40:43], s64 offen offset:0
    buffer_load_dwordx4 v[92:95], v3, s[28:31], s66 offen offset:0
    s_waitcnt vmcnt(26)
    v_mfma_f32_32x32x16_bf16 v[24:39], v[96:99], v[100:103], v[24:39]
    buffer_load_dwordx4 v[96:99], v3, s[40:43], s64 offen offset:1024
    buffer_load_dwordx4 v[100:103], v3, s[28:31], s66 offen offset:1024
    s_waitcnt vmcnt(26)
    v_mfma_f32_32x32x16_bf16 v[8:23], v[104:107], v[108:111], v[8:23]
    buffer_load_dwordx4 v[104:107], v3, s[40:43], s64 offen offset:2048
    buffer_load_dwordx4 v[108:111], v3, s[28:31], s66 offen offset:2048
    s_waitcnt vmcnt(26)
    v_mfma_f32_32x32x16_bf16 v[24:39], v[112:115], v[116:119], v[24:39]
    buffer_load_dwordx4 v[112:115], v3, s[40:43], s64 offen offset:3072
    buffer_load_dwordx4 v[116:119], v3, s[28:31], s66 offen offset:3072
    s_waitcnt vmcnt(26)
    v_mfma_f32_32x32x16_bf16 v[8:23], v[120:123], v[124:127], v[8:23]
    s_add_u32 s66, s67, 24576
    s_add_u32 s64, s65, 24576
    buffer_load_dwordx4 v[120:123], v3, s[40:43], s64 offen offset:0
    buffer_load_dwordx4 v[124:127], v3, s[28:31], s66 offen offset:0
    s_waitcnt vmcnt(26)
    v_mfma_f32_32x32x16_bf16 v[24:39], v[128:131], v[132:135], v[24:39]
    buffer_load_dwordx4 v[128:131], v3, s[40:43], s64 offen offset:1024
    buffer_load_dwordx4 v[132:135], v3, s[28:31], s66 offen offset:1024
    s_waitcnt vmcnt(26)
    v_mfma_f32_32x32x16_bf16 v[8:23], v[136:139], v[140:143], v[8:23]
    buffer_load_dwordx4 v[136:139], v3, s[40:43], s64 offen offset:2048
    buffer_load_dwordx4 v[140:143], v3, s[28:31], s66 offen offset:2048
    s_waitcnt vmcnt(26)
    v_mfma_f32_32x32x16_bf16 v[24:39], v[144:147], v[148:151], v[24:39]
    buffer_load_dwordx4 v[144:147], v3, s[40:43], s64 offen offset:3072
    buffer_load_dwordx4 v[148:151], v3, s[28:31], s66 offen offset:3072
    s_waitcnt vmcnt(26)
    v_mfma_f32_32x32x16_bf16 v[8:23], v[40:43], v[44:47], v[8:23]
    s_add_u32 s66, s67, 28672
    s_add_u32 s64, s65, 28672
    buffer_load_dwordx4 v[40:43], v3, s[40:43], s64 offen offset:0
    buffer_load_dwordx4 v[44:47], v3, s[28:31], s66 offen offset:0
    s_waitcnt vmcnt(26)
    v_mfma_f32_32x32x16_bf16 v[24:39], v[48:51], v[52:55], v[24:39]
    buffer_load_dwordx4 v[48:51], v3, s[40:43], s64 offen offset:1024
    buffer_load_dwordx4 v[52:55], v3, s[28:31], s66 offen offset:1024
    s_waitcnt vmcnt(26)
    v_mfma_f32_32x32x16_bf16 v[8:23], v[56:59], v[60:63], v[8:23]
    buffer_load_dwordx4 v[56:59], v3, s[40:43], s64 offen offset:2048
    buffer_load_dwordx4 v[60:63], v3, s[28:31], s66 offen offset:2048
    s_waitcnt vmcnt(26)
    v_mfma_f32_32x32x16_bf16 v[24:39], v[64:67], v[68:71], v[24:39]
    buffer_load_dwordx4 v[64:67], v3, s[40:43], s64 offen offset:3072
    buffer_load_dwordx4 v[68:71], v3, s[28:31], s66 offen offset:3072
    s_waitcnt vmcnt(26)
    v_mfma_f32_32x32x16_bf16 v[8:23], v[72:75], v[76:79], v[8:23]
    s_add_u32 s66, s67, 32768
    s_add_u32 s64, s65, 32768
    buffer_load_dwordx4 v[72:75], v3, s[40:43], s64 offen offset:0
    buffer_load_dwordx4 v[76:79], v3, s[28:31], s66 offen offset:0
    s_waitcnt vmcnt(26)
    v_mfma_f32_32x32x16_bf16 v[24:39], v[80:83], v[84:87], v[24:39]
    buffer_load_dwordx4 v[80:83], v3, s[40:43], s64 offen offset:1024
    buffer_load_dwordx4 v[84:87], v3, s[28:31], s66 offen offset:1024
    s_waitcnt vmcnt(26)
    v_mfma_f32_32x32x16_bf16 v[8:23], v[88:91], v[92:95], v[8:23]
    buffer_load_dwordx4 v[88:91], v3, s[40:43], s64 offen offset:2048
    buffer_load_dwordx4 v[92:95], v3, s[28:31], s66 offen offset:2048
    s_waitcnt vmcnt(26)
    v_mfma_f32_32x32x16_bf16 v[24:39], v[96:99], v[100:103], v[24:39]
    buffer_load_dwordx4 v[96:99], v3, s[40:43], s64 offen offset:3072
    buffer_load_dwordx4 v[100:103], v3, s[28:31], s66 offen offset:3072
    s_waitcnt vmcnt(26)
    v_mfma_f32_32x32x16_bf16 v[8:23], v[104:107], v[108:111], v[8:23]
    s_add_u32 s66, s67, 36864
    s_add_u32 s64, s65, 36864
    buffer_load_dwordx4 v[104:107], v3, s[40:43], s64 offen offset:0
    buffer_load_dwordx4 v[108:111], v3, s[28:31], s66 offen offset:0
    s_waitcnt vmcnt(26)
    v_mfma_f32_32x32x16_bf16 v[24:39], v[112:115], v[116:119], v[24:39]
    buffer_load_dwordx4 v[112:115], v3, s[40:43], s64 offen offset:1024
    buffer_load_dwordx4 v[116:119], v3, s[28:31], s66 offen offset:1024
    s_waitcnt vmcnt(26)
    v_mfma_f32_32x32x16_bf16 v[8:23], v[120:123], v[124:127], v[8:23]
    buffer_load_dwordx4 v[120:123], v3, s[40:43], s64 offen offset:2048
    buffer_load_dwordx4 v[124:127], v3, s[28:31], s66 offen offset:2048
    s_waitcnt vmcnt(26)
    v_mfma_f32_32x32x16_bf16 v[24:39], v[128:131], v[132:135], v[24:39]
    buffer_load_dwordx4 v[128:131], v3, s[40:43], s64 offen offset:3072
    buffer_load_dwordx4 v[132:135], v3, s[28:31], s66 offen offset:3072
    s_waitcnt vmcnt(26)
    v_mfma_f32_32x32x16_bf16 v[8:23], v[136:139], v[140:143], v[8:23]
    s_add_u32 s66, s67, 40960
    s_add_u32 s64, s65, 40960
    buffer_load_dwordx4 v[136:139], v3, s[40:43], s64 offen offset:0
    buffer_load_dwordx4 v[140:143], v3, s[28:31], s66 offen offset:0
    s_waitcnt vmcnt(26)
    v_mfma_f32_32x32x16_bf16 v[24:39], v[144:147], v[148:151], v[24:39]
    buffer_load_dwordx4 v[144:147], v3, s[40:43], s64 offen offset:1024
    buffer_load_dwordx4 v[148:151], v3, s[28:31], s66 offen offset:1024
    s_waitcnt vmcnt(26)
    v_mfma_f32_32x32x16_bf16 v[8:23], v[40:43], v[44:47], v[8:23]
    buffer_load_dwordx4 v[40:43], v3, s[40:43], s64 offen offset:2048
    buffer_load_dwordx4 v[44:47], v3, s[28:31], s66 offen offset:2048
    s_waitcnt vmcnt(26)
    v_mfma_f32_32x32x16_bf16 v[24:39], v[48:51], v[52:55], v[24:39]
    buffer_load_dwordx4 v[48:51], v3, s[40:43], s64 offen offset:3072
    buffer_load_dwordx4 v[52:55], v3, s[28:31], s66 offen offset:3072
    s_waitcnt vmcnt(26)
    v_mfma_f32_32x32x16_bf16 v[8:23], v[56:59], v[60:63], v[8:23]
    s_add_u32 s66, s67, 45056
    s_add_u32 s64, s65, 45056
    buffer_load_dwordx4 v[56:59], v3, s[40:43], s64 offen offset:0
    buffer_load_dwordx4 v[60:63], v3, s[28:31], s66 offen offset:0
    s_waitcnt vmcnt(26)
    v_mfma_f32_32x32x16_bf16 v[24:39], v[64:67], v[68:71], v[24:39]
    buffer_load_dwordx4 v[64:67], v3, s[40:43], s64 offen offset:1024
    buffer_load_dwordx4 v[68:71], v3, s[28:31], s66 offen offset:1024
    s_waitcnt vmcnt(26)
    v_mfma_f32_32x32x16_bf16 v[8:23], v[72:75], v[76:79], v[8:23]
    buffer_load_dwordx4 v[72:75], v3, s[40:43], s64 offen offset:2048
    buffer_load_dwordx4 v[76:79], v3, s[28:31], s66 offen offset:2048
    s_waitcnt vmcnt(26)
    v_mfma_f32_32x32x16_bf16 v[24:39], v[80:83], v[84:87], v[24:39]
    buffer_load_dwordx4 v[80:83], v3, s[40:43], s64 offen offset:3072
    buffer_load_dwordx4 v[84:87], v3, s[28:31], s66 offen offset:3072
    s_waitcnt vmcnt(26)
    v_mfma_f32_32x32x16_bf16 v[8:23], v[88:91], v[92:95], v[8:23]
    s_add_u32 s66, s67, 49152
    s_add_u32 s64, s65, 49152
    buffer_load_dwordx4 v[88:91], v3, s[40:43], s64 offen offset:0
    buffer_load_dwordx4 v[92:95], v3, s[28:31], s66 offen offset:0
    s_waitcnt vmcnt(26)
    v_mfma_f32_32x32x16_bf16 v[24:39], v[96:99], v[100:103], v[24:39]
    buffer_load_dwordx4 v[96:99], v3, s[40:43], s64 offen offset:1024
    buffer_load_dwordx4 v[100:103], v3, s[28:31], s66 offen offset:1024
    s_waitcnt vmcnt(26)
    v_mfma_f32_32x32x16_bf16 v[8:23], v[104:107], v[108:111], v[8:23]
    buffer_load_dwordx4 v[104:107], v3, s[40:43], s64 offen offset:2048
    buffer_load_dwordx4 v[108:111], v3, s[28:31], s66 offen offset:2048
    s_waitcnt vmcnt(26)
    v_mfma_f32_32x32x16_bf16 v[24:39], v[112:115], v[116:119], v[24:39]
    buffer_load_dwordx4 v[112:115], v3, s[40:43], s64 offen offset:3072
    buffer_load_dwordx4 v[116:119], v3, s[28:31], s66 offen offset:3072
    s_waitcnt vmcnt(26)
    v_mfma_f32_32x32x16_bf16 v[8:23], v[120:123], v[124:127], v[8:23]
    s_add_u32 s66, s67, 53248
    s_add_u32 s64, s65, 53248
    buffer_load_dwordx4 v[120:123], v3, s[40:43], s64 offen offset:0
    buffer_load_dwordx4 v[124:127], v3, s[28:31], s66 offen offset:0
    s_waitcnt vmcnt(26)
    v_mfma_f32_32x32x16_bf16 v[24:39], v[128:131], v[132:135], v[24:39]
    buffer_load_dwordx4 v[128:131], v3, s[40:43], s64 offen offset:1024
    buffer_load_dwordx4 v[132:135], v3, s[28:31], s66 offen offset:1024
    s_waitcnt vmcnt(26)
    v_mfma_f32_32x32x16_bf16 v[8:23], v[136:139], v[140:143], v[8:23]
    buffer_load_dwordx4 v[136:139], v3, s[40:43], s64 offen offset:2048
    buffer_load_dwordx4 v[140:143], v3, s[28:31], s66 offen offset:2048
    s_waitcnt vmcnt(26)
    v_mfma_f32_32x32x16_bf16 v[24:39], v[144:147], v[148:151], v[24:39]
    buffer_load_dwordx4 v[144:147], v3, s[40:43], s64 offen offset:3072
    buffer_load_dwordx4 v[148:151], v3, s[28:31], s66 offen offset:3072
    s_waitcnt vmcnt(26)
    v_mfma_f32_32x32x16_bf16 v[8:23], v[40:43], v[44:47], v[8:23]
    s_add_u32 s66, s67, 57344
    s_add_u32 s64, s65, 57344
    buffer_load_dwordx4 v[40:43], v3, s[40:43], s64 offen offset:0
    buffer_load_dwordx4 v[44:47], v3, s[28:31], s66 offen offset:0
    s_waitcnt vmcnt(26)
    v_mfma_f32_32x32x16_bf16 v[24:39], v[48:51], v[52:55], v[24:39]
    buffer_load_dwordx4 v[48:51], v3, s[40:43], s64 offen offset:1024
    buffer_load_dwordx4 v[52:55], v3, s[28:31], s66 offen offset:1024
    s_waitcnt vmcnt(26)
    v_mfma_f32_32x32x16_bf16 v[8:23], v[56:59], v[60:63], v[8:23]
    buffer_load_dwordx4 v[56:59], v3, s[40:43], s64 offen offset:2048
    buffer_load_dwordx4 v[60:63], v3, s[28:31], s66 offen offset:2048
    s_waitcnt vmcnt(26)
    v_mfma_f32_32x32x16_bf16 v[24:39], v[64:67], v[68:71], v[24:39]
    buffer_load_dwordx4 v[64:67], v3, s[40:43], s64 offen offset:3072
    buffer_load_dwordx4 v[68:71], v3, s[28:31], s66 offen offset:3072
    s_waitcnt vmcnt(26)
    v_mfma_f32_32x32x16_bf16 v[8:23], v[72:75], v[76:79], v[8:23]
    s_add_u32 s66, s67, 61440
    s_add_u32 s64, s65, 61440
    buffer_load_dwordx4 v[72:75], v3, s[40:43], s64 offen offset:0
    buffer_load_dwordx4 v[76:79], v3, s[28:31], s66 offen offset:0
    s_waitcnt vmcnt(26)
    v_mfma_f32_32x32x16_bf16 v[24:39], v[80:83], v[84:87], v[24:39]
    buffer_load_dwordx4 v[80:83], v3, s[40:43], s64 offen offset:1024
    buffer_load_dwordx4 v[84:87], v3, s[28:31], s66 offen offset:1024
    s_waitcnt vmcnt(26)
    v_mfma_f32_32x32x16_bf16 v[8:23], v[88:91], v[92:95], v[8:23]
    buffer_load_dwordx4 v[88:91], v3, s[40:43], s64 offen offset:2048
    buffer_load_dwordx4 v[92:95], v3, s[28:31], s66 offen offset:2048
    s_waitcnt vmcnt(26)
    v_mfma_f32_32x32x16_bf16 v[24:39], v[96:99], v[100:103], v[24:39]
    buffer_load_dwordx4 v[96:99], v3, s[40:43], s64 offen offset:3072
    buffer_load_dwordx4 v[100:103], v3, s[28:31], s66 offen offset:3072
    s_waitcnt vmcnt(26)
    v_mfma_f32_32x32x16_bf16 v[8:23], v[104:107], v[108:111], v[8:23]
    s_waitcnt vmcnt(24)
    v_mfma_f32_32x32x16_bf16 v[24:39], v[112:115], v[116:119], v[24:39]
    s_waitcnt vmcnt(22)
    v_mfma_f32_32x32x16_bf16 v[8:23], v[120:123], v[124:127], v[8:23]
    s_waitcnt vmcnt(20)
    v_mfma_f32_32x32x16_bf16 v[24:39], v[128:131], v[132:135], v[24:39]
    s_waitcnt vmcnt(18)
    v_mfma_f32_32x32x16_bf16 v[8:23], v[136:139], v[140:143], v[8:23]
    s_waitcnt vmcnt(16)
    v_mfma_f32_32x32x16_bf16 v[24:39], v[144:147], v[148:151], v[24:39]
    s_waitcnt vmcnt(14)
    v_mfma_f32_32x32x16_bf16 v[8:23], v[40:43], v[44:47], v[8:23]
    s_waitcnt vmcnt(12)
    v_mfma_f32_32x32x16_bf16 v[24:39], v[48:51], v[52:55], v[24:39]
    s_waitcnt vmcnt(10)
    v_mfma_f32_32x32x16_bf16 v[8:23], v[56:59], v[60:63], v[8:23]
    s_waitcnt vmcnt(8)
    v_mfma_f32_32x32x16_bf16 v[24:39], v[64:67], v[68:71], v[24:39]
    s_waitcnt vmcnt(6)
    v_mfma_f32_32x32x16_bf16 v[8:23], v[72:75], v[76:79], v[8:23]
    s_waitcnt vmcnt(4)
    v_mfma_f32_32x32x16_bf16 v[24:39], v[80:83], v[84:87], v[24:39]
    s_waitcnt vmcnt(2)
    v_mfma_f32_32x32x16_bf16 v[8:23], v[88:91], v[92:95], v[8:23]
    s_waitcnt vmcnt(0)
    v_mfma_f32_32x32x16_bf16 v[24:39], v[96:99], v[100:103], v[24:39]
    s_setprio 1
    v_lshlrev_b32 v7, 16, v7
    v_sub_u32 v47, 640, v4
    v_lshrrev_b32 v45, 4, v4
    v_lshlrev_b32 v45, 10, v45
    v_bfe_u32 v46, v4, 2, 2
    v_lshl_add_u32 v45, v46, 8, v45
    v_and_b32 v46, 3, v4
    v_lshl_add_u32 v40, v46, 1, v45
    v_lshrrev_b32 v45, 4, v47
    v_lshlrev_b32 v45, 10, v45
    v_bfe_u32 v46, v47, 2, 2
    v_lshl_add_u32 v45, v46, 8, v45
    v_and_b32 v46, 3, v47
    v_lshl_add_u32 v41, v46, 1, v45
    v_mov_b32 v42, 1073741824
    v_cmp_lt_u32 vcc, 320, v4
    v_add_u32 v44, -1, v4
    s_mul_i32 s61, s62, 81920
    v_cndmask_b32 v40, v40, v42, vcc
    v_cmp_lt_u32 vcc, 318, v44
    v_lshl_add_u32 v45, v5, 6, s61
    s_nop 0
    v_cndmask_b32 v41, v41, v42, vcc
    v_add_u32 v48, v45, v40
    v_add_u32 v49, v45, v41
    s_cmp_eq_u32 s62, 16
    s_cbranch_scc0 L_dft_full
    s_mov_b64 exec, 0xffffffff
L_dft_full:
    s_cmp_lg_u32 s52, 8
    s_cbranch_scc1 L_dft_Q
    v_add_f32 v8, v8, v7
    s_mov_b32 s65, 0
    v_add_f32 v52, v8, v24
    v_sub_f32 v53, v8, v24
    s_mov_b32 s66, 1351680
    v_cvt_pk_bf16_f32 v56, v52, v53
    buffer_store_short v56, v48, s[36:39], s65 offen
    buffer_store_short v56, v49, s[36:39], s65 offen
    s_cmp_eq_u32 s62, 16
    s_cbranch_scc1 L_dft_end
    buffer_store_short_d16_hi v56, v48, s[36:39], s66 offen
    buffer_store_short_d16_hi v56, v49, s[36:39], s66 offen
    v_sub_f32 v9, v9, v7
    s_mov_b32 s65, 16
    v_add_f32 v52, v9, v25
    v_sub_f32 v53, v9, v25
    s_mov_b32 s66, 1351696
    v_cvt_pk_bf16_f32 v57, v52, v53
    buffer_store_short v57, v48, s[36:39], s65 offen
    buffer_store_short v57, v49, s[36:39], s65 offen
    buffer_store_short_d16_hi v57, v48, s[36:39], s66 offen
    buffer_store_short_d16_hi v57, v49, s[36:39], s66 offen
    v_add_f32 v10, v10, v7
    s_mov_b32 s65, 32
    v_add_f32 v52, v10, v26
    v_sub_f32 v53, v10, v26
    s_mov_b32 s66, 1351712
    v_cvt_pk_bf16_f32 v58, v52, v53
    buffer_store_short v58, v48, s[36:39], s65 offen
    buffer_store_short v58, v49, s[36:39], s65 offen
    buffer_store_short_d16_hi v58, v48, s[36:39], s66 offen
    buffer_store_short_d16_hi v58, v49, s[36:39], s66 offen
    v_sub_f32 v11, v11, v7
    s_mov_b32 s65, 48
    v_add_f32 v52, v11, v27
    v_sub_f32 v53, v11, v27
    s_mov_b32 s66, 1351728
    v_cvt_pk_bf16_f32 v59, v52, v53
    buffer_store_short v59, v48, s[36:39], s65 offen
    buffer_store_short v59, v49, s[36:39], s65 offen
    buffer_store_short_d16_hi v59, v48, s[36:39], s66 offen
    buffer_store_short_d16_hi v59, v49, s[36:39], s66 offen
    v_add_f32 v12, v12, v7
    s_mov_b32 s65, 128
    v_add_f32 v52, v12, v28
    v_sub_f32 v53, v12, v28
    s_mov_b32 s66, 1351808
    v_cvt_pk_bf16_f32 v60, v52, v53
    buffer_store_short v60, v48, s[36:39], s65 offen
    buffer_store_short v60, v49, s[36:39], s65 offen
    buffer_store_short_d16_hi v60, v48, s[36:39], s66 offen
    buffer_store_short_d16_hi v60, v49, s[36:39], s66 offen
    v_sub_f32 v13, v13, v7
    s_mov_b32 s65, 144
    v_add_f32 v52, v13, v29
    v_sub_f32 v53, v13, v29
    s_mov_b32 s66, 1351824
    v_cvt_pk_bf16_f32 v61, v52, v53
    buffer_store_short v61, v48, s[36:39], s65 offen
    buffer_store_short v61, v49, s[36:39], s65 offen
    buffer_store_short_d16_hi v61, v48, s[36:39], s66 offen
    buffer_store_short_d16_hi v61, v49, s[36:39], s66 offen
    v_add_f32 v14, v14, v7
    s_mov_b32 s65, 160
    v_add_f32 v52, v14, v30
    v_sub_f32 v53, v14, v30
    s_mov_b32 s66, 1351840
    v_cvt_pk_bf16_f32 v62, v52, v53
    buffer_store_short v62, v48, s[36:39], s65 offen
    buffer_store_short v62, v49, s[36:39], s65 offen
    buffer_store_short_d16_hi v62, v48, s[36:39], s66 offen
    buffer_store_short_d16_hi v62, v49, s[36:39], s66 offen
    v_sub_f32 v15, v15, v7
    s_mov_b32 s65, 176
    v_add_f32 v52, v15, v31
    v_sub_f32 v53, v15, v31
    s_mov_b32 s66, 1351856
    v_cvt_pk_bf16_f32 v63, v52, v53
    buffer_store_short v63, v48, s[36:39], s65 offen
    buffer_store_short v63, v49, s[36:39], s65 offen
    buffer_store_short_d16_hi v63, v48, s[36:39], s66 offen
    buffer_store_short_d16_hi v63, v49, s[36:39], s66 offen
    v_add_f32 v16, v16, v7
    s_mov_b32 s65, 40960
    v_add_f32 v52, v16, v32
    v_sub_f32 v53, v16, v32
    s_mov_b32 s66, 1392640
    v_cvt_pk_bf16_f32 v56, v52, v53
    buffer_store_short v56, v48, s[36:39], s65 offen
    buffer_store_short v56, v49, s[36:39], s65 offen
    buffer_store_short_d16_hi v56, v48, s[36:39], s66 offen
    buffer_store_short_d16_hi v56, v49, s[36:39], s66 offen
    v_sub_f32 v17, v17, v7
    s_mov_b32 s65, 40976
    v_add_f32 v52, v17, v33
    v_sub_f32 v53, v17, v33
    s_mov_b32 s66, 1392656
    v_cvt_pk_bf16_f32 v57, v52, v53
    buffer_store_short v57, v48, s[36:39], s65 offen
    buffer_store_short v57, v49, s[36:39], s65 offen
    buffer_store_short_d16_hi v57, v48, s[36:39], s66 offen
    buffer_store_short_d16_hi v57, v49, s[36:39], s66 offen
    v_add_f32 v18, v18, v7
    s_mov_b32 s65, 40992
    v_add_f32 v52, v18, v34
    v_sub_f32 v53, v18, v34
    s_mov_b32 s66, 1392672
    v_cvt_pk_bf16_f32 v58, v52, v53
    buffer_store_short v58, v48, s[36:39], s65 offen
    buffer_store_short v58, v49, s[36:39], s65 offen
    buffer_store_short_d16_hi v58, v48, s[36:39], s66 offen
    buffer_store_short_d16_hi v58, v49, s[36:39], s66 offen
    v_sub_f32 v19, v19, v7
    s_mov_b32 s65, 41008
    v_add_f32 v52, v19, v35
    v_sub_f32 v53, v19, v35
    s_mov_b32 s66, 1392688
    v_cvt_pk_bf16_f32 v59, v52, v53
    buffer_store_short v59, v48, s[36:39], s65 offen
    buffer_store_short v59, v49, s[36:39], s65 offen
    buffer_store_short_d16_hi v59, v48, s[36:39], s66 offen
    buffer_store_short_d16_hi v59, v49, s[36:39], s66 offen
    v_add_f32 v20, v20, v7
    s_mov_b32 s65, 41088
    v_add_f32 v52, v20, v36
    v_sub_f32 v53, v20, v36
    s_mov_b32 s66, 1392768
    v_cvt_pk_bf16_f32 v60, v52, v53
    buffer_store_short v60, v48, s[36:39], s65 offen
    buffer_store_short v60, v49, s[36:39], s65 offen
    buffer_store_short_d16_hi v60, v48, s[36:39], s66 offen
    buffer_store_short_d16_hi v60, v49, s[36:39], s66 offen
    v_sub_f32 v21, v21, v7
    s_mov_b32 s65, 41104
    v_add_f32 v52, v21, v37
    v_sub_f32 v53, v21, v37
    s_mov_b32 s66, 1392784
    v_cvt_pk_bf16_f32 v61, v52, v53
    buffer_store_short v61, v48, s[36:39], s65 offen
    buffer_store_short v61, v49, s[36:39], s65 offen
    buffer_store_short_d16_hi v61, v48, s[36:39], s66 offen
    buffer_store_short_d16_hi v61, v49, s[36:39], s66 offen
    v_add_f32 v22, v22, v7
    s_mov_b32 s65, 41120
    v_add_f32 v52, v22, v38
    v_sub_f32 v53, v22, v38
    s_mov_b32 s66, 1392800
    v_cvt_pk_bf16_f32 v62, v52, v53
    buffer_store_short v62, v48, s[36:39], s65 offen
    buffer_store_short v62, v49, s[36:39], s65 offen
    buffer_store_short_d16_hi v62, v48, s[36:39], s66 offen
    buffer_store_short_d16_hi v62, v49, s[36:39], s66 offen
    v_sub_f32 v23, v23, v7
    s_mov_b32 s65, 41136
    v_add_f32 v52, v23, v39
    v_sub_f32 v53, v23, v39
    s_mov_b32 s66, 1392816
    v_cvt_pk_bf16_f32 v63, v52, v53
    buffer_store_short v63, v48, s[36:39], s65 offen
    buffer_store_short v63, v49, s[36:39], s65 offen
    buffer_store_short_d16_hi v63, v48, s[36:39], s66 offen
    buffer_store_short_d16_hi v63, v49, s[36:39], s66 offen
    s_branch L_dft_end
L_dft_Q:
    s_mov_b32 s65, 0
    v_add_f32 v52, v8, v24
    v_sub_f32 v53, v24, v8
    s_mov_b32 s66, 1351680
    v_cvt_pk_bf16_f32 v56, v52, v53
    v_cndmask_b32 v56, v56, 0, vcc
    v_xor_b32 v57, 0x80008000, v56
    buffer_store_short v56, v48, s[36:39], s65 offen
    buffer_store_short v57, v49, s[36:39], s65 offen
    s_cmp_eq_u32 s62, 16
    s_cbranch_scc1 L_dft_end
    buffer_store_short_d16_hi v56, v48, s[36:39], s66 offen
    buffer_store_short_d16_hi v57, v49, s[36:39], s66 offen
    s_mov_b32 s65, 16
    v_add_f32 v52, v9, v25
    v_sub_f32 v53, v25, v9
    s_mov_b32 s66, 1351696
    v_cvt_pk_bf16_f32 v58, v52, v53
    v_cndmask_b32 v58, v58, 0, vcc
    v_xor_b32 v59, 0x80008000, v58
    buffer_store_short v58, v48, s[36:39], s65 offen
    buffer_store_short v59, v49, s[36:39], s65 offen
    buffer_store_short_d16_hi v58, v48, s[36:39], s66 offen
    buffer_store_short_d16_hi v59, v49, s[36:39], s66 offen
    s_mov_b32 s65, 32
    v_add_f32 v52, v10, v26
    v_sub_f32 v53, v26, v10
    s_mov_b32 s66, 1351712
    v_cvt_pk_bf16_f32 v60, v52, v53
    v_cndmask_b32 v60, v60, 0, vcc
    v_xor_b32 v61, 0x80008000, v60
    buffer_store_short v60, v48, s[36:39], s65 offen
    buffer_store_short v61, v49, s[36:39], s65 offen
    buffer_store_short_d16_hi v60, v48, s[36:39], s66 offen
    buffer_store_short_d16_hi v61, v49, s[36:39], s66 offen
    s_mov_b32 s65, 48
    v_add_f32 v52, v11, v27
    v_sub_f32 v53, v27, v11
    s_mov_b32 s66, 1351728
    v_cvt_pk_bf16_f32 v62, v52, v53
    v_cndmask_b32 v62, v62, 0, vcc
    v_xor_b32 v63, 0x80008000, v62
    buffer_store_short v62, v48, s[36:39], s65 offen
    buffer_store_short v63, v49, s[36:39], s65 offen
    buffer_store_short_d16_hi v62, v48, s[36:39], s66 offen
    buffer_store_short_d16_hi v63, v49, s[36:39], s66 offen
    s_mov_b32 s65, 128
    v_add_f32 v52, v12, v28
    v_sub_f32 v53, v28, v12
    s_mov_b32 s66, 1351808
    v_cvt_pk_bf16_f32 v64, v52, v53
    v_cndmask_b32 v64, v64, 0, vcc
    v_xor_b32 v65, 0x80008000, v64
    buffer_store_short v64, v48, s[36:39], s65 offen
    buffer_store_short v65, v49, s[36:39], s65 offen
    buffer_store_short_d16_hi v64, v48, s[36:39], s66 offen
    buffer_store_short_d16_hi v65, v49, s[36:39], s66 offen
    s_mov_b32 s65, 144
    v_add_f32 v52, v13, v29
    v_sub_f32 v53, v29, v13
    s_mov_b32 s66, 1351824
    v_cvt_pk_bf16_f32 v66, v52, v53
    v_cndmask_b32 v66, v66, 0, vcc
    v_xor_b32 v67, 0x80008000, v66
    buffer_store_short v66, v48, s[36:39], s65 offen
    buffer_store_short v67, v49, s[36:39], s65 offen
    buffer_store_short_d16_hi v66, v48, s[36:39], s66 offen
    buffer_store_short_d16_hi v67, v49, s[36:39], s66 offen
    s_mov_b32 s65, 160
    v_add_f32 v52, v14, v30
    v_sub_f32 v53, v30, v14
    s_mov_b32 s66, 1351840
    v_cvt_pk_bf16_f32 v68, v52, v53
    v_cndmask_b32 v68, v68, 0, vcc
    v_xor_b32 v69, 0x80008000, v68
    buffer_store_short v68, v48, s[36:39], s65 offen
    buffer_store_short v69, v49, s[36:39], s65 offen
    buffer_store_short_d16_hi v68, v48, s[36:39], s66 offen
    buffer_store_short_d16_hi v69, v49, s[36:39], s66 offen
    s_mov_b32 s65, 176
    v_add_f32 v52, v15, v31
    v_sub_f32 v53, v31, v15
    s_mov_b32 s66, 1351856
    v_cvt_pk_bf16_f32 v70, v52, v53
    v_cndmask_b32 v70, v70, 0, vcc
    v_xor_b32 v71, 0x80008000, v70
    buffer_store_short v70, v48, s[36:39], s65 offen
    buffer_store_short v71, v49, s[36:39], s65 offen
    buffer_store_short_d16_hi v70, v48, s[36:39], s66 offen
    buffer_store_short_d16_hi v71, v49, s[36:39], s66 offen
    s_mov_b32 s65, 40960
    v_add_f32 v52, v16, v32
    v_sub_f32 v53, v32, v16
    s_mov_b32 s66, 1392640
    v_cvt_pk_bf16_f32 v56, v52, v53
    v_cndmask_b32 v56, v56, 0, vcc
    v_xor_b32 v57, 0x80008000, v56
    buffer_store_short v56, v48, s[36:39], s65 offen
    buffer_store_short v57, v49, s[36:39], s65 offen
    buffer_store_short_d16_hi v56, v48, s[36:39], s66 offen
    buffer_store_short_d16_hi v57, v49, s[36:39], s66 offen
    s_mov_b32 s65, 40976
    v_add_f32 v52, v17, v33
    v_sub_f32 v53, v33, v17
    s_mov_b32 s66, 1392656
    v_cvt_pk_bf16_f32 v58, v52, v53
    v_cndmask_b32 v58, v58, 0, vcc
    v_xor_b32 v59, 0x80008000, v58
    buffer_store_short v58, v48, s[36:39], s65 offen
    buffer_store_short v59, v49, s[36:39], s65 offen
    buffer_store_short_d16_hi v58, v48, s[36:39], s66 offen
    buffer_store_short_d16_hi v59, v49, s[36:39], s66 offen
    s_mov_b32 s65, 40992
    v_add_f32 v52, v18, v34
    v_sub_f32 v53, v34, v18
    s_mov_b32 s66, 1392672
    v_cvt_pk_bf16_f32 v60, v52, v53
    v_cndmask_b32 v60, v60, 0, vcc
    v_xor_b32 v61, 0x80008000, v60
    buffer_store_short v60, v48, s[36:39], s65 offen
    buffer_store_short v61, v49, s[36:39], s65 offen
    buffer_store_short_d16_hi v60, v48, s[36:39], s66 offen
    buffer_store_short_d16_hi v61, v49, s[36:39], s66 offen
    s_mov_b32 s65, 41008
    v_add_f32 v52, v19, v35
    v_sub_f32 v53, v35, v19
    s_mov_b32 s66, 1392688
    v_cvt_pk_bf16_f32 v62, v52, v53
    v_cndmask_b32 v62, v62, 0, vcc
    v_xor_b32 v63, 0x80008000, v62
    buffer_store_short v62, v48, s[36:39], s65 offen
    buffer_store_short v63, v49, s[36:39], s65 offen
    buffer_store_short_d16_hi v62, v48, s[36:39], s66 offen
    buffer_store_short_d16_hi v63, v49, s[36:39], s66 offen
    s_mov_b32 s65, 41088
    v_add_f32 v52, v20, v36
    v_sub_f32 v53, v36, v20
    s_mov_b32 s66, 1392768
    v_cvt_pk_bf16_f32 v64, v52, v53
    v_cndmask_b32 v64, v64, 0, vcc
    v_xor_b32 v65, 0x80008000, v64
    buffer_store_short v64, v48, s[36:39], s65 offen
    buffer_store_short v65, v49, s[36:39], s65 offen
    buffer_store_short_d16_hi v64, v48, s[36:39], s66 offen
    buffer_store_short_d16_hi v65, v49, s[36:39], s66 offen
    s_mov_b32 s65, 41104
    v_add_f32 v52, v21, v37
    v_sub_f32 v53, v37, v21
    s_mov_b32 s66, 1392784
    v_cvt_pk_bf16_f32 v66, v52, v53
    v_cndmask_b32 v66, v66, 0, vcc
    v_xor_b32 v67, 0x80008000, v66
    buffer_store_short v66, v48, s[36:39], s65 offen
    buffer_store_short v67, v49, s[36:39], s65 offen
    buffer_store_short_d16_hi v66, v48, s[36:39], s66 offen
    buffer_store_short_d16_hi v67, v49, s[36:39], s66 offen
    s_mov_b32 s65, 41120
    v_add_f32 v52, v22, v38
    v_sub_f32 v53, v38, v22
    s_mov_b32 s66, 1392800
    v_cvt_pk_bf16_f32 v68, v52, v53
    v_cndmask_b32 v68, v68, 0, vcc
    v_xor_b32 v69, 0x80008000, v68
    buffer_store_short v68, v48, s[36:39], s65 offen
    buffer_store_short v69, v49, s[36:39], s65 offen
    buffer_store_short_d16_hi v68, v48, s[36:39], s66 offen
    buffer_store_short_d16_hi v69, v49, s[36:39], s66 offen
    s_mov_b32 s65, 41136
    v_add_f32 v52, v23, v39
    v_sub_f32 v53, v39, v23
    s_mov_b32 s66, 1392816
    v_cvt_pk_bf16_f32 v70, v52, v53
    v_cndmask_b32 v70, v70, 0, vcc
    v_xor_b32 v71, 0x80008000, v70
    buffer_store_short v70, v48, s[36:39], s65 offen
    buffer_store_short v71, v49, s[36:39], s65 offen
    buffer_store_short_d16_hi v70, v48, s[36:39], s66 offen
    buffer_store_short_d16_hi v71, v49, s[36:39], s66 offen
L_dft_end:
    s_mov_b64 exec, -1
    s_endpgm
L_k2_gate:
    s_mov_b32 s40, s68
    s_mov_b32 s41, s69
    s_mov_b32 s42, 2621440
    s_mov_b32 s43, 0x00020000
    s_mov_b32 s44, s76
    s_mov_b32 s45, s77
    s_mov_b32 s46, 1280
    s_mov_b32 s47, 0x00020000
    s_add_u32 s48, s4, 14811136
    s_addc_u32 s49, s5, 0
    s_mov_b32 s50, 8192
    s_mov_b32 s51, 0x00020000
    v_lshrrev_b32 v2, 3, v1
    v_and_b32 v3, 7, v1
    s_lshl_b32 s60, s2, 3
    v_add_u32 v2, s60, v2
    v_mul_u32_u24 v4, 160, v3
    v_mul_u32_u24 v5, 1280, v2
    v_add_u32 v5, v5, v4
    buffer_load_dwordx4 v[8:11], v5, s[40:43], 0 offen offset:0
    buffer_load_dwordx4 v[48:51], v4, s[44:47], 0 offen offset:0
    buffer_load_dwordx4 v[12:15], v5, s[40:43], 0 offen offset:16
    buffer_load_dwordx4 v[52:55], v4, s[44:47], 0 offen offset:16
    buffer_load_dwordx4 v[16:19], v5, s[40:43], 0 offen offset:32
    buffer_load_dwordx4 v[56:59], v4, s[44:47], 0 offen offset:32
    buffer_load_dwordx4 v[20:23], v5, s[40:43], 0 offen offset:48
    buffer_load_dwordx4 v[60:63], v4, s[44:47], 0 offen offset:48
    buffer_load_dwordx4 v[24:27], v5, s[40:43], 0 offen offset:64
    buffer_load_dwordx4 v[64:67], v4, s[44:47], 0 offen offset:64
    buffer_load_dwordx4 v[28:31], v5, s[40:43], 0 offen offset:80
    buffer_load_dwordx4 v[68:71], v4, s[44:47], 0 offen offset:80
    buffer_load_dwordx4 v[32:35], v5, s[40:43], 0 offen offset:96
    buffer_load_dwordx4 v[72:75], v4, s[44:47], 0 offen offset:96
    buffer_load_dwordx4 v[36:39], v5, s[40:43], 0 offen offset:112
    buffer_load_dwordx4 v[76:79], v4, s[44:47], 0 offen offset:112
    buffer_load_dwordx4 v[40:43], v5, s[40:43], 0 offen offset:128
    buffer_load_dwordx4 v[80:83], v4, s[44:47], 0 offen offset:128
    buffer_load_dwordx4 v[44:47], v5, s[40:43], 0 offen offset:144
    buffer_load_dwordx4 v[84:87], v4, s[44:47], 0 offen offset:144
    v_mov_b32 v6, 0
    v_mov_b32 v7, 0
    s_waitcnt vmcnt(0)
    v_dot2_f32_bf16 v6, v8, v48, v6
    v_dot2_f32_bf16 v7, v9, v49, v7
    v_dot2_f32_bf16 v6, v10, v50, v6
    v_dot2_f32_bf16 v7, v11, v51, v7
    v_dot2_f32_bf16 v6, v12, v52, v6
    v_dot2_f32_bf16 v7, v13, v53, v7
    v_dot2_f32_bf16 v6, v14, v54, v6
    v_dot2_f32_bf16 v7, v15, v55, v7
    v_dot2_f32_bf16 v6, v16, v56, v6
    v_dot2_f32_bf16 v7, v17, v57, v7
    v_dot2_f32_bf16 v6, v18, v58, v6
    v_dot2_f32_bf16 v7, v19, v59, v7
    v_dot2_f32_bf16 v6, v20, v60, v6
    v_dot2_f32_bf16 v7, v21, v61, v7
    v_dot2_f32_bf16 v6, v22, v62, v6
    v_dot2_f32_bf16 v7, v23, v63, v7
    v_dot2_f32_bf16 v6, v24, v64, v6
    v_dot2_f32_bf16 v7, v25, v65, v7
    v_dot2_f32_bf16 v6, v26, v66, v6
    v_dot2_f32_bf16 v7, v27, v67, v7
    v_dot2_f32_bf16 v6, v28, v68, v6
    v_dot2_f32_bf16 v7, v29, v69, v7
    v_dot2_f32_bf16 v6, v30, v70, v6
    v_dot2_f32_bf16 v7, v31, v71, v7
    v_dot2_f32_bf16 v6, v32, v72, v6
    v_dot2_f32_bf16 v7, v33, v73, v7
    v_dot2_f32_bf16 v6, v34, v74, v6
    v_dot2_f32_bf16 v7, v35, v75, v7
    v_dot2_f32_bf16 v6, v36, v76, v6
    v_dot2_f32_bf16 v7, v37, v77, v7
    v_dot2_f32_bf16 v6, v38, v78, v6
    v_dot2_f32_bf16 v7, v39, v79, v7
    v_dot2_f32_bf16 v6, v40, v80, v6
    v_dot2_f32_bf16 v7, v41, v81, v7
    v_dot2_f32_bf16 v6, v42, v82, v6
    v_dot2_f32_bf16 v7, v43, v83, v7
    v_dot2_f32_bf16 v6, v44, v84, v6
    v_dot2_f32_bf16 v7, v45, v85, v7
    v_dot2_f32_bf16 v6, v46, v86, v6
    v_dot2_f32_bf16 v7, v47, v87, v7
    s_nop 3
    v_add_f32 v6, v6, v7
    s_nop 1
    v_add_f32_dpp v6, v6, v6 quad_perm:[1,0,3,2] row_mask:0xf bank_mask:0xf
    s_nop 1
    v_add_f32_dpp v6, v6, v6 quad_perm:[2,3,0,1] row_mask:0xf bank_mask:0xf
    s_nop 1
    v_add_f32_dpp v6, v6, v6 row_half_mirror row_mask:0xf bank_mask:0xf
    v_mul_f32 v6, 3216550459, v6
    v_exp_f32 v6, v6
    s_nop 0
    v_add_f32 v6, 1.0, v6
    v_rcp_f32 v6, v6
    v_lshlrev_b32 v2, 2, v2
    v_cmp_eq_u32 vcc, 0, v3
    s_and_saveexec_b64 s[66:67], vcc
    buffer_store_dword v6, v2, s[48:51], 0 offen
    s_mov_b64 exec, -1
    s_endpgm
L_k2_wopack:
    s_mov_b32 s40, s70
    s_mov_b32 s41, s71
    s_mov_b32 s42, 819200
    s_mov_b32 s43, 0x00020000
    s_add_u32 s44, s4, 14876672
    s_addc_u32 s45, s5, 0
    s_mov_b32 s46, 819200
    s_mov_b32 s47, 0x00020000
    v_and_b32 v2, 15, v1
    v_lshrrev_b32 v3, 4, v1
    v_mul_u32_u24 v3, 10240, v3
    v_lshl_add_u32 v3, v2, 1, v3
    v_add_u32 v4, 5120, v3
    v_lshlrev_b32 v5, 4, v1
    s_add_u32 s60, s2, 0
    s_mul_i32 s61, s60, 3277
    s_lshr_b32 s61, s61, 16
    s_mul_i32 s62, s61, 20
    s_sub_u32 s62, s60, s62
    s_mul_i32 s62, s62, 40960
    s_lshl_b32 s61, s61, 5
    s_add_u32 s62, s62, s61
    s_lshl_b32 s63, s60, 10
    buffer_load_ushort v24, v3, s[40:43], s62 offen offset:0
    buffer_load_ushort v25, v3, s[40:43], s62 offen offset:1280
    buffer_load_ushort v26, v3, s[40:43], s62 offen offset:2560
    buffer_load_ushort v27, v3, s[40:43], s62 offen offset:3840
    buffer_load_ushort v28, v4, s[40:43], s62 offen offset:0
    buffer_load_ushort v29, v4, s[40:43], s62 offen offset:1280
    buffer_load_ushort v30, v4, s[40:43], s62 offen offset:2560
    buffer_load_ushort v31, v4, s[40:43], s62 offen offset:3840
    s_add_u32 s60, s2, 256
    s_mul_i32 s61, s60, 3277
    s_lshr_b32 s61, s61, 16
    s_mul_i32 s62, s61, 20
    s_sub_u32 s62, s60, s62
    s_mul_i32 s62, s62, 40960
    s_lshl_b32 s61, s61, 5
    s_add_u32 s62, s62, s61
    s_lshl_b32 s64, s60, 10
    buffer_load_ushort v32, v3, s[40:43], s62 offen offset:0
    buffer_load_ushort v33, v3, s[40:43], s62 offen offset:1280
    buffer_load_ushort v34, v3, s[40:43], s62 offen offset:2560
    buffer_load_ushort v35, v3, s[40:43], s62 offen offset:3840
    buffer_load_ushort v36, v4, s[40:43], s62 offen offset:0
    buffer_load_ushort v37, v4, s[40:43], s62 offen offset:1280
    buffer_load_ushort v38, v4, s[40:43], s62 offen offset:2560
    buffer_load_ushort v39, v4, s[40:43], s62 offen offset:3840
    s_add_u32 s60, s2, 512
    s_mul_i32 s61, s60, 3277
    s_lshr_b32 s61, s61, 16
    s_mul_i32 s62, s61, 20
    s_sub_u32 s62, s60, s62
    s_mul_i32 s62, s62, 40960
    s_lshl_b32 s61, s61, 5
    s_add_u32 s62, s62, s61
    s_lshl_b32 s65, s60, 10
    buffer_load_ushort v40, v3, s[40:43], s62 offen offset:0
    buffer_load_ushort v41, v3, s[40:43], s62 offen offset:1280
    buffer_load_ushort v42, v3, s[40:43], s62 offen offset:2560
    buffer_load_ushort v43, v3, s[40:43], s62 offen offset:3840
    buffer_load_ushort v44, v4, s[40:43], s62 offen offset:0
    buffer_load_ushort v45, v4, s[40:43], s62 offen offset:1280
    buffer_load_ushort v46, v4, s[40:43], s62 offen offset:2560
    buffer_load_ushort v47, v4, s[40:43], s62 offen offset:3840
    s_add_u32 s60, s2, 768
    s_mul_i32 s61, s60, 3277
    s_lshr_b32 s61, s61, 16
    s_mul_i32 s62, s61, 20
    s_sub_u32 s62, s60, s62
    s_mul_i32 s62, s62, 40960
    s_lshl_b32 s61, s61, 5
    s_add_u32 s62, s62, s61
    s_lshl_b32 s66, s60, 10
    buffer_load_ushort v48, v3, s[40:43], s62 offen offset:0
    buffer_load_ushort v49, v3, s[40:43], s62 offen offset:1280
    buffer_load_ushort v50, v3, s[40:43], s62 offen offset:2560
    buffer_load_ushort v51, v3, s[40:43], s62 offen offset:3840
    buffer_load_ushort v52, v4, s[40:43], s62 offen offset:0
    buffer_load_ushort v53, v4, s[40:43], s62 offen offset:1280
    buffer_load_ushort v54, v4, s[40:43], s62 offen offset:2560
    buffer_load_ushort v55, v4, s[40:43], s62 offen offset:3840
    s_waitcnt vmcnt(0)
    v_lshl_or_b32 v8, v25, 16, v24
    v_lshl_or_b32 v9, v27, 16, v26
    v_lshl_or_b32 v10, v29, 16, v28
    v_lshl_or_b32 v11, v31, 16, v30
    buffer_store_dwordx4 v[8:11], v5, s[44:47], s63 offen
    v_lshl_or_b32 v12, v33, 16, v32
    v_lshl_or_b32 v13, v35, 16, v34
    v_lshl_or_b32 v14, v37, 16, v36
    v_lshl_or_b32 v15, v39, 16, v38
    buffer_store_dwordx4 v[12:15], v5, s[44:47], s64 offen
    v_lshl_or_b32 v16, v41, 16, v40
    v_lshl_or_b32 v17, v43, 16, v42
    v_lshl_or_b32 v18, v45, 16, v44
    v_lshl_or_b32 v19, v47, 16, v46
    buffer_store_dwordx4 v[16:19], v5, s[44:47], s65 offen
    v_lshl_or_b32 v20, v49, 16, v48
    v_lshl_or_b32 v21, v51, 16, v50
    v_lshl_or_b32 v22, v53, 16, v52
    v_lshl_or_b32 v23, v55, 16, v54
    buffer_store_dwordx4 v[20:23], v5, s[44:47], s66 offen
    s_endpgm
L_k2_exit:
    s_endpgm
.globl outproj_mix_kernel
.p2align 8
.type outproj_mix_kernel,@function
outproj_mix_kernel:
    s_cmp_ge_u32 s2, 256
    s_cbranch_scc1 L_k3_exit
    s_load_dwordx2 s[4:5], s[0:1], 88
    s_load_dwordx2 s[6:7], s[0:1], 72
    v_and_b32 v1, 63, v0
    v_lshrrev_b32 v2, 6, v0
    s_nop 0
    v_readfirstlane_b32 s36, v2
    s_and_b32 s39, s36, 3
    s_and_b32 s44, s2, 3
    s_lshl_b32 s44, s44, 3
    s_bfe_u32 s45, s2, 0x30003
    s_add_u32 s37, s44, s45
    s_and_b32 s44, s2, 4
    s_lshr_b32 s45, s2, 6
    s_add_u32 s38, s44, s45
    v_and_b32 v2, 15, v1
    v_lshrrev_b32 v3, 4, v1
    v_lshlrev_b32 v9, 4, v1
    s_lshl_b32 s46, s37, 2
    s_add_u32 s46, s46, s39
    s_lshl_b32 s50, s46, 4
    s_mul_i32 s46, s46, 20480
    s_mul_i32 s47, s38, 102400
    s_lshl_b32 s48, s39, 10
    s_add_u32 s47, s47, s48
    s_mul_i32 s48, s39, 5120
    v_add_u32 v11, s50, v2
    v_mul_u32_u24 v10, 1280, v11
    s_mul_i32 s49, s38, 160
    v_lshl_add_u32 v10, v3, 3, v10
    v_add_u32 v10, s49, v10
    s_movk_i32 s56, 512
    v_sub_u32 v4, 2048, v11
    v_min_u32 v4, v4, v11
    v_cmp_lt_u32 vcc, 1024, v11
    v_sub_u32 v5, 1024, v4
    v_min_u32 v5, v5, v4
    v_lshrrev_b32 v6, 4, v5
    v_mul_u32_u24 v6, 40960, v6
    v_and_b32 v5, 15, v5
    v_lshl_add_u32 v5, v3, 4, v5
    v_lshl_add_u32 v7, v5, 4, v6
    s_mul_i32 s53, s38, 5120
    v_add_u32 v7, s53, v7
    v_add_u32 v6, 1351680, v7
    v_cmp_lt_u32 s[54:55], s56, v4
    s_nop 1
    v_cndmask_b32 v7, v7, v6, s[54:55]
    v_cndmask_b32 v163, -1.0, 1.0, vcc
    v_lshlrev_b32 v11, 2, v11
    v_add_u32 v8, 61440, v9
    s_waitcnt lgkmcnt(0)
    s_add_u32 s12, s4, 14876672
    s_addc_u32 s13, s5, 0
    s_mov_b32 s14, 819200
    s_mov_b32 s15, 0x00020000
    s_add_u32 s8, s4, 12189696
    s_addc_u32 s9, s5, 0
    s_mov_b32 s10, 2621440
    s_mov_b32 s11, 0x00020000
    s_cmp_ge_u32 s36, 4
    s_cbranch_scc0 L_k3_comp
    s_add_u32 m0, s48, 0
    s_add_u32 s51, s47, 0
    buffer_load_dwordx4 v9, s[12:15], s51 offen lds
    s_add_u32 m0, s48, 1024
    s_add_u32 s51, s47, 20480
    buffer_load_dwordx4 v9, s[12:15], s51 offen lds
    s_add_u32 m0, s48, 2048
    s_add_u32 s51, s47, 40960
    buffer_load_dwordx4 v9, s[12:15], s51 offen lds
    s_add_u32 m0, s48, 3072
    s_add_u32 s51, s47, 61440
    buffer_load_dwordx4 v9, s[12:15], s51 offen lds
    s_add_u32 m0, s48, 4096
    s_add_u32 s51, s47, 81920
    buffer_load_dwordx4 v9, s[12:15], s51 offen lds
    s_add_u32 m0, s48, 20480
    s_add_u32 s51, s47, 4096
    buffer_load_dwordx4 v9, s[12:15], s51 offen lds
    s_add_u32 m0, s48, 21504
    s_add_u32 s51, s47, 24576
    buffer_load_dwordx4 v9, s[12:15], s51 offen lds
    s_add_u32 m0, s48, 22528
    s_add_u32 s51, s47, 45056
    buffer_load_dwordx4 v9, s[12:15], s51 offen lds
    s_add_u32 m0, s48, 23552
    s_add_u32 s51, s47, 65536
    buffer_load_dwordx4 v9, s[12:15], s51 offen lds
    s_add_u32 m0, s48, 24576
    s_add_u32 s51, s47, 86016
    buffer_load_dwordx4 v9, s[12:15], s51 offen lds
    s_waitcnt vmcnt(5)
    s_barrier
    s_add_u32 m0, s48, 40960
    s_add_u32 s51, s47, 8192
    buffer_load_dwordx4 v9, s[12:15], s51 offen lds
    s_add_u32 m0, s48, 41984
    s_add_u32 s51, s47, 28672
    buffer_load_dwordx4 v9, s[12:15], s51 offen lds
    s_add_u32 m0, s48, 43008
    s_add_u32 s51, s47, 49152
    buffer_load_dwordx4 v9, s[12:15], s51 offen lds
    s_add_u32 m0, s48, 44032
    s_add_u32 s51, s47, 69632
    buffer_load_dwordx4 v9, s[12:15], s51 offen lds
    s_add_u32 m0, s48, 45056
    s_add_u32 s51, s47, 90112
    buffer_load_dwordx4 v9, s[12:15], s51 offen lds
    s_waitcnt vmcnt(5)
    s_barrier
    s_add_u32 m0, s48, 61440
    s_add_u32 s51, s47, 12288
    buffer_load_dwordx4 v9, s[12:15], s51 offen lds
    s_add_u32 m0, s48, 62464
    s_add_u32 s51, s47, 32768
    buffer_load_dwordx4 v9, s[12:15], s51 offen lds
    s_add_u32 m0, s48, 63488
    s_add_u32 s51, s47, 53248
    buffer_load_dwordx4 v9, s[12:15], s51 offen lds
    s_add_u32 m0, s48, 64512
    s_add_u32 s51, s47, 73728
    buffer_load_dwordx4 v9, s[12:15], s51 offen lds
    s_add_u32 m0, s48, 65536
    s_add_u32 s51, s47, 94208
    buffer_load_dwordx4 v9, s[12:15], s51 offen lds
    s_waitcnt vmcnt(5)
    s_barrier
    s_add_u32 m0, s48, 81920
    s_add_u32 s51, s47, 16384
    buffer_load_dwordx4 v9, s[12:15], s51 offen lds
    s_add_u32 m0, s48, 82944
    s_add_u32 s51, s47, 36864
    buffer_load_dwordx4 v9, s[12:15], s51 offen lds
    s_add_u32 m0, s48, 83968
    s_add_u32 s51, s47, 57344
    buffer_load_dwordx4 v9, s[12:15], s51 offen lds
    s_add_u32 m0, s48, 84992
    s_add_u32 s51, s47, 77824
    buffer_load_dwordx4 v9, s[12:15], s51 offen lds
    s_add_u32 m0, s48, 86016
    s_add_u32 s51, s47, 98304
    buffer_load_dwordx4 v9, s[12:15], s51 offen lds
    s_waitcnt vmcnt(5)
    s_barrier
    s_waitcnt vmcnt(0)
    s_barrier
    s_endpgm
L_k3_comp:
    s_add_u32 s51, s46, 0
    buffer_load_dwordx4 v[32:35], v9, s[8:11], s51 offen offset:0
    buffer_load_dwordx4 v[36:39], v9, s[8:11], s51 offen offset:1024
    buffer_load_dwordx4 v[40:43], v9, s[8:11], s51 offen offset:2048
    buffer_load_dwordx4 v[44:47], v9, s[8:11], s51 offen offset:3072
    s_add_u32 s16, s4, 9437184
    s_addc_u32 s17, s5, 0
    s_mov_b32 s18, 2752512
    s_mov_b32 s19, 0x00020000
    s_add_u32 s20, s4, 14811136
    s_addc_u32 s21, s5, 0
    s_mov_b32 s22, 8192
    s_mov_b32 s23, 0x00020000
    s_mov_b32 s24, s6
    s_mov_b32 s25, s7
    s_mov_b32 s26, 2621440
    s_mov_b32 s27, 0x00020000
    s_add_u32 s51, s46, 4096
    buffer_load_dwordx4 v[48:51], v9, s[8:11], s51 offen offset:0
    buffer_load_dwordx4 v[52:55], v9, s[8:11], s51 offen offset:1024
    buffer_load_dwordx4 v[56:59], v9, s[8:11], s51 offen offset:2048
    buffer_load_dwordx4 v[60:63], v9, s[8:11], s51 offen offset:3072
    s_waitcnt vmcnt(4)
    s_barrier
    s_add_u32 s51, s46, 8192
    buffer_load_dwordx4 v[64:67], v9, s[8:11], s51 offen offset:0
    buffer_load_dwordx4 v[68:71], v9, s[8:11], s51 offen offset:1024
    buffer_load_dwordx4 v[72:75], v9, s[8:11], s51 offen offset:2048
    buffer_load_dwordx4 v[76:79], v9, s[8:11], s51 offen offset:3072
    ds_read_b128 v[112:115], v9 offset:0
    ds_read_b128 v[116:119], v9 offset:1024
    ds_read_b128 v[120:123], v9 offset:2048
    ds_read_b128 v[124:127], v9 offset:3072
    ds_read_b128 v[128:131], v9 offset:4096
    ds_read_b128 v[132:135], v9 offset:5120
    ds_read_b128 v[136:139], v9 offset:6144
    ds_read_b128 v[140:143], v9 offset:7168
    ds_read_b128 v[144:147], v9 offset:8192
    ds_read_b128 v[148:151], v9 offset:9216
    s_waitcnt lgkmcnt(5)
    v_mfma_f32_16x16x32_bf16 v[12:15], v[112:115], v[32:35], 0
    v_mfma_f32_16x16x32_bf16 v[16:19], v[116:119], v[32:35], 0
    v_mfma_f32_16x16x32_bf16 v[20:23], v[120:123], v[32:35], 0
    v_mfma_f32_16x16x32_bf16 v[24:27], v[124:127], v[32:35], 0
    v_mfma_f32_16x16x32_bf16 v[28:31], v[128:131], v[32:35], 0
    ds_read_b128 v[112:115], v9 offset:10240
    ds_read_b128 v[116:119], v9 offset:11264
    ds_read_b128 v[120:123], v9 offset:12288
    ds_read_b128 v[124:127], v9 offset:13312
    ds_read_b128 v[128:131], v9 offset:14336
    s_waitcnt lgkmcnt(5)
    v_mfma_f32_16x16x32_bf16 v[12:15], v[132:135], v[36:39], v[12:15]
    v_mfma_f32_16x16x32_bf16 v[16:19], v[136:139], v[36:39], v[16:19]
    v_mfma_f32_16x16x32_bf16 v[20:23], v[140:143], v[36:39], v[20:23]
    v_mfma_f32_16x16x32_bf16 v[24:27], v[144:147], v[36:39], v[24:27]
    v_mfma_f32_16x16x32_bf16 v[28:31], v[148:151], v[36:39], v[28:31]
    ds_read_b128 v[132:135], v9 offset:15360
    ds_read_b128 v[136:139], v9 offset:16384
    ds_read_b128 v[140:143], v9 offset:17408
    ds_read_b128 v[144:147], v9 offset:18432
    ds_read_b128 v[148:151], v9 offset:19456
    s_waitcnt lgkmcnt(5)
    v_mfma_f32_16x16x32_bf16 v[12:15], v[112:115], v[40:43], v[12:15]
    v_mfma_f32_16x16x32_bf16 v[16:19], v[116:119], v[40:43], v[16:19]
    v_mfma_f32_16x16x32_bf16 v[20:23], v[120:123], v[40:43], v[20:23]
    v_mfma_f32_16x16x32_bf16 v[24:27], v[124:127], v[40:43], v[24:27]
    v_mfma_f32_16x16x32_bf16 v[28:31], v[128:131], v[40:43], v[28:31]
    s_waitcnt vmcnt(4)
    s_barrier
    s_add_u32 s51, s46, 12288
    buffer_load_dwordx4 v[80:83], v9, s[8:11], s51 offen offset:0
    buffer_load_dwordx4 v[84:87], v9, s[8:11], s51 offen offset:1024
    buffer_load_dwordx4 v[88:91], v9, s[8:11], s51 offen offset:2048
    buffer_load_dwordx4 v[92:95], v9, s[8:11], s51 offen offset:3072
    ds_read_b128 v[112:115], v9 offset:20480
    ds_read_b128 v[116:119], v9 offset:21504
    ds_read_b128 v[120:123], v9 offset:22528
    ds_read_b128 v[124:127], v9 offset:23552
    ds_read_b128 v[128:131], v9 offset:24576
    s_waitcnt lgkmcnt(5)
    v_mfma_f32_16x16x32_bf16 v[12:15], v[132:135], v[44:47], v[12:15]
    v_mfma_f32_16x16x32_bf16 v[16:19], v[136:139], v[44:47], v[16:19]
    v_mfma_f32_16x16x32_bf16 v[20:23], v[140:143], v[44:47], v[20:23]
    v_mfma_f32_16x16x32_bf16 v[24:27], v[144:147], v[44:47], v[24:27]
    v_mfma_f32_16x16x32_bf16 v[28:31], v[148:151], v[44:47], v[28:31]
    ds_read_b128 v[132:135], v9 offset:25600
    ds_read_b128 v[136:139], v9 offset:26624
    ds_read_b128 v[140:143], v9 offset:27648
    ds_read_b128 v[144:147], v9 offset:28672
    ds_read_b128 v[148:151], v9 offset:29696
    s_waitcnt lgkmcnt(5)
    v_mfma_f32_16x16x32_bf16 v[12:15], v[112:115], v[48:51], v[12:15]
    v_mfma_f32_16x16x32_bf16 v[16:19], v[116:119], v[48:51], v[16:19]
    v_mfma_f32_16x16x32_bf16 v[20:23], v[120:123], v[48:51], v[20:23]
    v_mfma_f32_16x16x32_bf16 v[24:27], v[124:127], v[48:51], v[24:27]
    v_mfma_f32_16x16x32_bf16 v[28:31], v[128:131], v[48:51], v[28:31]
    ds_read_b128 v[112:115], v9 offset:30720
    ds_read_b128 v[116:119], v9 offset:31744
    ds_read_b128 v[120:123], v9 offset:32768
    ds_read_b128 v[124:127], v9 offset:33792
    ds_read_b128 v[128:131], v9 offset:34816
    s_waitcnt lgkmcnt(5)
    v_mfma_f32_16x16x32_bf16 v[12:15], v[132:135], v[52:55], v[12:15]
    v_mfma_f32_16x16x32_bf16 v[16:19], v[136:139], v[52:55], v[16:19]
    v_mfma_f32_16x16x32_bf16 v[20:23], v[140:143], v[52:55], v[20:23]
    v_mfma_f32_16x16x32_bf16 v[24:27], v[144:147], v[52:55], v[24:27]
    v_mfma_f32_16x16x32_bf16 v[28:31], v[148:151], v[52:55], v[28:31]
    ds_read_b128 v[132:135], v9 offset:35840
    ds_read_b128 v[136:139], v9 offset:36864
    ds_read_b128 v[140:143], v9 offset:37888
    ds_read_b128 v[144:147], v9 offset:38912
    ds_read_b128 v[148:151], v9 offset:39936
    s_waitcnt lgkmcnt(5)
    v_mfma_f32_16x16x32_bf16 v[12:15], v[112:115], v[56:59], v[12:15]
    v_mfma_f32_16x16x32_bf16 v[16:19], v[116:119], v[56:59], v[16:19]
    v_mfma_f32_16x16x32_bf16 v[20:23], v[120:123], v[56:59], v[20:23]
    v_mfma_f32_16x16x32_bf16 v[24:27], v[124:127], v[56:59], v[24:27]
    v_mfma_f32_16x16x32_bf16 v[28:31], v[128:131], v[56:59], v[28:31]
    s_waitcnt vmcnt(4)
    s_barrier
    s_add_u32 s51, s46, 16384
    buffer_load_dwordx4 v[96:99], v9, s[8:11], s51 offen offset:0
    buffer_load_dwordx4 v[100:103], v9, s[8:11], s51 offen offset:1024
    buffer_load_dwordx4 v[104:107], v9, s[8:11], s51 offen offset:2048
    buffer_load_dwordx4 v[108:111], v9, s[8:11], s51 offen offset:3072
    s_mov_b32 s53, 0
    buffer_load_dwordx4 v[164:167], v7, s[16:19], s53 offen offset:0
    buffer_load_dwordx4 v[168:171], v7, s[16:19], s53 offen offset:1024
    buffer_load_dwordx4 v[172:175], v7, s[16:19], s53 offen offset:2048
    buffer_load_dwordx4 v[176:179], v7, s[16:19], s53 offen offset:3072
    s_movk_i32 s53, 4096
    buffer_load_dwordx4 v[180:183], v7, s[16:19], s53 offen offset:0
    buffer_load_dword v162, v11, s[20:23], 0 offen
    ds_read_b128 v[112:115], v9 offset:40960
    ds_read_b128 v[116:119], v9 offset:41984
    ds_read_b128 v[120:123], v9 offset:43008
    ds_read_b128 v[124:127], v9 offset:44032
    ds_read_b128 v[128:131], v9 offset:45056
    s_waitcnt lgkmcnt(5)
    v_mfma_f32_16x16x32_bf16 v[12:15], v[132:135], v[60:63], v[12:15]
    v_mfma_f32_16x16x32_bf16 v[16:19], v[136:139], v[60:63], v[16:19]
    v_mfma_f32_16x16x32_bf16 v[20:23], v[140:143], v[60:63], v[20:23]
    v_mfma_f32_16x16x32_bf16 v[24:27], v[144:147], v[60:63], v[24:27]
    v_mfma_f32_16x16x32_bf16 v[28:31], v[148:151], v[60:63], v[28:31]
    ds_read_b128 v[132:135], v9 offset:46080
    ds_read_b128 v[136:139], v9 offset:47104
    ds_read_b128 v[140:143], v9 offset:48128
    ds_read_b128 v[144:147], v9 offset:49152
    ds_read_b128 v[148:151], v9 offset:50176
    s_waitcnt lgkmcnt(5)
    v_mfma_f32_16x16x32_bf16 v[12:15], v[112:115], v[64:67], v[12:15]
    v_mfma_f32_16x16x32_bf16 v[16:19], v[116:119], v[64:67], v[16:19]
    v_mfma_f32_16x16x32_bf16 v[20:23], v[120:123], v[64:67], v[20:23]
    v_mfma_f32_16x16x32_bf16 v[24:27], v[124:127], v[64:67], v[24:27]
    v_mfma_f32_16x16x32_bf16 v[28:31], v[128:131], v[64:67], v[28:31]
    ds_read_b128 v[112:115], v9 offset:51200
    ds_read_b128 v[116:119], v9 offset:52224
    ds_read_b128 v[120:123], v9 offset:53248
    ds_read_b128 v[124:127], v9 offset:54272
    ds_read_b128 v[128:131], v9 offset:55296
    s_waitcnt lgkmcnt(5)
    v_mfma_f32_16x16x32_bf16 v[12:15], v[132:135], v[68:71], v[12:15]
    v_mfma_f32_16x16x32_bf16 v[16:19], v[136:139], v[68:71], v[16:19]
    v_mfma_f32_16x16x32_bf16 v[20:23], v[140:143], v[68:71], v[20:23]
    v_mfma_f32_16x16x32_bf16 v[24:27], v[144:147], v[68:71], v[24:27]
    v_mfma_f32_16x16x32_bf16 v[28:31], v[148:151], v[68:71], v[28:31]
    ds_read_b128 v[132:135], v9 offset:56320
    ds_read_b128 v[136:139], v9 offset:57344
    ds_read_b128 v[140:143], v9 offset:58368
    ds_read_b128 v[144:147], v9 offset:59392
    ds_read_b128 v[148:151], v9 offset:60416
    s_waitcnt lgkmcnt(5)
    v_mfma_f32_16x16x32_bf16 v[12:15], v[112:115], v[72:75], v[12:15]
    v_mfma_f32_16x16x32_bf16 v[16:19], v[116:119], v[72:75], v[16:19]
    v_mfma_f32_16x16x32_bf16 v[20:23], v[120:123], v[72:75], v[20:23]
    v_mfma_f32_16x16x32_bf16 v[24:27], v[124:127], v[72:75], v[24:27]
    v_mfma_f32_16x16x32_bf16 v[28:31], v[128:131], v[72:75], v[28:31]
    s_waitcnt vmcnt(10)
    s_barrier
    ds_read_b128 v[112:115], v8 offset:0
    ds_read_b128 v[116:119], v8 offset:1024
    ds_read_b128 v[120:123], v8 offset:2048
    ds_read_b128 v[124:127], v8 offset:3072
    ds_read_b128 v[128:131], v8 offset:4096
    s_waitcnt lgkmcnt(5)
    v_mfma_f32_16x16x32_bf16 v[12:15], v[132:135], v[76:79], v[12:15]
    v_mfma_f32_16x16x32_bf16 v[16:19], v[136:139], v[76:79], v[16:19]
    v_mfma_f32_16x16x32_bf16 v[20:23], v[140:143], v[76:79], v[20:23]
    v_mfma_f32_16x16x32_bf16 v[24:27], v[144:147], v[76:79], v[24:27]
    v_mfma_f32_16x16x32_bf16 v[28:31], v[148:151], v[76:79], v[28:31]
    ds_read_b128 v[132:135], v8 offset:5120
    ds_read_b128 v[136:139], v8 offset:6144
    ds_read_b128 v[140:143], v8 offset:7168
    ds_read_b128 v[144:147], v8 offset:8192
    ds_read_b128 v[148:151], v8 offset:9216
    s_waitcnt lgkmcnt(5)
    v_mfma_f32_16x16x32_bf16 v[12:15], v[112:115], v[80:83], v[12:15]
    v_mfma_f32_16x16x32_bf16 v[16:19], v[116:119], v[80:83], v[16:19]
    v_mfma_f32_16x16x32_bf16 v[20:23], v[120:123], v[80:83], v[20:23]
    v_mfma_f32_16x16x32_bf16 v[24:27], v[124:127], v[80:83], v[24:27]
    v_mfma_f32_16x16x32_bf16 v[28:31], v[128:131], v[80:83], v[28:31]
    ds_read_b128 v[112:115], v8 offset:10240
    ds_read_b128 v[116:119], v8 offset:11264
    ds_read_b128 v[120:123], v8 offset:12288
    ds_read_b128 v[124:127], v8 offset:13312
    ds_read_b128 v[128:131], v8 offset:14336
    s_waitcnt lgkmcnt(5)
    v_mfma_f32_16x16x32_bf16 v[12:15], v[132:135], v[84:87], v[12:15]
    v_mfma_f32_16x16x32_bf16 v[16:19], v[136:139], v[84:87], v[16:19]
    v_mfma_f32_16x16x32_bf16 v[20:23], v[140:143], v[84:87], v[20:23]
    v_mfma_f32_16x16x32_bf16 v[24:27], v[144:147], v[84:87], v[24:27]
    v_mfma_f32_16x16x32_bf16 v[28:31], v[148:151], v[84:87], v[28:31]
    ds_read_b128 v[132:135], v8 offset:15360
    ds_read_b128 v[136:139], v8 offset:16384
    ds_read_b128 v[140:143], v8 offset:17408
    ds_read_b128 v[144:147], v8 offset:18432
    ds_read_b128 v[148:151], v8 offset:19456
    s_waitcnt lgkmcnt(5)
    v_mfma_f32_16x16x32_bf16 v[12:15], v[112:115], v[88:91], v[12:15]
    v_mfma_f32_16x16x32_bf16 v[16:19], v[116:119], v[88:91], v[16:19]
    v_mfma_f32_16x16x32_bf16 v[20:23], v[120:123], v[88:91], v[20:23]
    v_mfma_f32_16x16x32_bf16 v[24:27], v[124:127], v[88:91], v[24:27]
    v_mfma_f32_16x16x32_bf16 v[28:31], v[128:131], v[88:91], v[28:31]
    s_waitcnt vmcnt(6)
    s_barrier
    ds_read_b128 v[112:115], v8 offset:20480
    ds_read_b128 v[116:119], v8 offset:21504
    ds_read_b128 v[120:123], v8 offset:22528
    ds_read_b128 v[124:127], v8 offset:23552
    ds_read_b128 v[128:131], v8 offset:24576
    s_waitcnt lgkmcnt(5)
    v_mfma_f32_16x16x32_bf16 v[12:15], v[132:135], v[92:95], v[12:15]
    v_mfma_f32_16x16x32_bf16 v[16:19], v[136:139], v[92:95], v[16:19]
    v_mfma_f32_16x16x32_bf16 v[20:23], v[140:143], v[92:95], v[20:23]
    v_mfma_f32_16x16x32_bf16 v[24:27], v[144:147], v[92:95], v[24:27]
    v_mfma_f32_16x16x32_bf16 v[28:31], v[148:151], v[92:95], v[28:31]
    ds_read_b128 v[132:135], v8 offset:25600
    ds_read_b128 v[136:139], v8 offset:26624
    ds_read_b128 v[140:143], v8 offset:27648
    ds_read_b128 v[144:147], v8 offset:28672
    ds_read_b128 v[148:151], v8 offset:29696
    s_waitcnt lgkmcnt(5)
    v_mfma_f32_16x16x32_bf16 v[12:15], v[112:115], v[96:99], v[12:15]
    v_mfma_f32_16x16x32_bf16 v[16:19], v[116:119], v[96:99], v[16:19]
    v_mfma_f32_16x16x32_bf16 v[20:23], v[120:123], v[96:99], v[20:23]
    v_mfma_f32_16x16x32_bf16 v[24:27], v[124:127], v[96:99], v[24:27]
    v_mfma_f32_16x16x32_bf16 v[28:31], v[128:131], v[96:99], v[28:31]
    ds_read_b128 v[112:115], v8 offset:30720
    ds_read_b128 v[116:119], v8 offset:31744
    ds_read_b128 v[120:123], v8 offset:32768
    ds_read_b128 v[124:127], v8 offset:33792
    ds_read_b128 v[128:131], v8 offset:34816
    s_waitcnt lgkmcnt(5)
    v_mfma_f32_16x16x32_bf16 v[12:15], v[132:135], v[100:103], v[12:15]
    v_mfma_f32_16x16x32_bf16 v[16:19], v[136:139], v[100:103], v[16:19]
    v_mfma_f32_16x16x32_bf16 v[20:23], v[140:143], v[100:103], v[20:23]
    v_mfma_f32_16x16x32_bf16 v[24:27], v[144:147], v[100:103], v[24:27]
    v_mfma_f32_16x16x32_bf16 v[28:31], v[148:151], v[100:103], v[28:31]
    ds_read_b128 v[132:135], v8 offset:35840
    ds_read_b128 v[136:139], v8 offset:36864
    ds_read_b128 v[140:143], v8 offset:37888
    ds_read_b128 v[144:147], v8 offset:38912
    ds_read_b128 v[148:151], v8 offset:39936
    s_waitcnt lgkmcnt(5)
    v_mfma_f32_16x16x32_bf16 v[12:15], v[112:115], v[104:107], v[12:15]
    v_mfma_f32_16x16x32_bf16 v[16:19], v[116:119], v[104:107], v[16:19]
    v_mfma_f32_16x16x32_bf16 v[20:23], v[120:123], v[104:107], v[20:23]
    v_mfma_f32_16x16x32_bf16 v[24:27], v[124:127], v[104:107], v[24:27]
    v_mfma_f32_16x16x32_bf16 v[28:31], v[128:131], v[104:107], v[28:31]
    s_waitcnt lgkmcnt(0)
    v_mfma_f32_16x16x32_bf16 v[12:15], v[132:135], v[108:111], v[12:15]
    v_mfma_f32_16x16x32_bf16 v[16:19], v[136:139], v[108:111], v[16:19]
    v_mfma_f32_16x16x32_bf16 v[20:23], v[140:143], v[108:111], v[20:23]
    v_mfma_f32_16x16x32_bf16 v[24:27], v[144:147], v[108:111], v[24:27]
    v_mfma_f32_16x16x32_bf16 v[28:31], v[148:151], v[108:111], v[28:31]
    s_waitcnt vmcnt(0)
    v_lshlrev_b32 v36, 16, v164
    v_and_b32 v37, 0xffff0000, v164
    v_lshlrev_b32 v38, 16, v165
    v_and_b32 v39, 0xffff0000, v165
    v_lshlrev_b32 v80, 16, v166
    v_and_b32 v81, 0xffff0000, v166
    v_lshlrev_b32 v82, 16, v167
    v_and_b32 v83, 0xffff0000, v167
    v_fma_f32 v36, v80, v163, v36
    v_fma_f32 v37, v81, v163, v37
    v_fma_f32 v38, v82, v163, v38
    v_fma_f32 v39, v83, v163, v39
    v_lshlrev_b32 v40, 16, v168
    v_and_b32 v41, 0xffff0000, v168
    v_lshlrev_b32 v42, 16, v169
    v_and_b32 v43, 0xffff0000, v169
    v_lshlrev_b32 v84, 16, v170
    v_and_b32 v85, 0xffff0000, v170
    v_lshlrev_b32 v86, 16, v171
    v_and_b32 v87, 0xffff0000, v171
    v_fma_f32 v40, v84, v163, v40
    v_fma_f32 v41, v85, v163, v41
    v_fma_f32 v42, v86, v163, v42
    v_fma_f32 v43, v87, v163, v43
    v_lshlrev_b32 v44, 16, v172
    v_and_b32 v45, 0xffff0000, v172
    v_lshlrev_b32 v46, 16, v173
    v_and_b32 v47, 0xffff0000, v173
    v_lshlrev_b32 v88, 16, v174
    v_and_b32 v89, 0xffff0000, v174
    v_lshlrev_b32 v90, 16, v175
    v_and_b32 v91, 0xffff0000, v175
    v_fma_f32 v44, v88, v163, v44
    v_fma_f32 v45, v89, v163, v45
    v_fma_f32 v46, v90, v163, v46
    v_fma_f32 v47, v91, v163, v47
    v_lshlrev_b32 v48, 16, v176
    v_and_b32 v49, 0xffff0000, v176
    v_lshlrev_b32 v50, 16, v177
    v_and_b32 v51, 0xffff0000, v177
    v_lshlrev_b32 v92, 16, v178
    v_and_b32 v93, 0xffff0000, v178
    v_lshlrev_b32 v94, 16, v179
    v_and_b32 v95, 0xffff0000, v179
    v_fma_f32 v48, v92, v163, v48
    v_fma_f32 v49, v93, v163, v49
    v_fma_f32 v50, v94, v163, v50
    v_fma_f32 v51, v95, v163, v51
    v_lshlrev_b32 v52, 16, v180
    v_and_b32 v53, 0xffff0000, v180
    v_lshlrev_b32 v54, 16, v181
    v_and_b32 v55, 0xffff0000, v181
    v_lshlrev_b32 v96, 16, v182
    v_and_b32 v97, 0xffff0000, v182
    v_lshlrev_b32 v98, 16, v183
    v_and_b32 v99, 0xffff0000, v183
    v_fma_f32 v52, v96, v163, v52
    v_fma_f32 v53, v97, v163, v53
    v_fma_f32 v54, v98, v163, v54
    v_fma_f32 v55, v99, v163, v55
    v_sub_f32 v12, v12, v36
    v_fma_f32 v12, v12, v162, v36
    v_sub_f32 v13, v13, v37
    v_fma_f32 v13, v13, v162, v37
    v_sub_f32 v14, v14, v38
    v_fma_f32 v14, v14, v162, v38
    v_sub_f32 v15, v15, v39
    v_fma_f32 v15, v15, v162, v39
    v_cvt_pk_bf16_f32 v60, v12, v13
    v_cvt_pk_bf16_f32 v61, v14, v15
    buffer_store_dwordx2 v[60:61], v10, s[24:27], 0 offen offset:0
    v_sub_f32 v16, v16, v40
    v_fma_f32 v16, v16, v162, v40
    v_sub_f32 v17, v17, v41
    v_fma_f32 v17, v17, v162, v41
    v_sub_f32 v18, v18, v42
    v_fma_f32 v18, v18, v162, v42
    v_sub_f32 v19, v19, v43
    v_fma_f32 v19, v19, v162, v43
    v_cvt_pk_bf16_f32 v62, v16, v17
    v_cvt_pk_bf16_f32 v63, v18, v19
    buffer_store_dwordx2 v[62:63], v10, s[24:27], 0 offen offset:32
    v_sub_f32 v20, v20, v44
    v_fma_f32 v20, v20, v162, v44
    v_sub_f32 v21, v21, v45
    v_fma_f32 v21, v21, v162, v45
    v_sub_f32 v22, v22, v46
    v_fma_f32 v22, v22, v162, v46
    v_sub_f32 v23, v23, v47
    v_fma_f32 v23, v23, v162, v47
    v_cvt_pk_bf16_f32 v64, v20, v21
    v_cvt_pk_bf16_f32 v65, v22, v23
    buffer_store_dwordx2 v[64:65], v10, s[24:27], 0 offen offset:64
    v_sub_f32 v24, v24, v48
    v_fma_f32 v24, v24, v162, v48
    v_sub_f32 v25, v25, v49
    v_fma_f32 v25, v25, v162, v49
    v_sub_f32 v26, v26, v50
    v_fma_f32 v26, v26, v162, v50
    v_sub_f32 v27, v27, v51
    v_fma_f32 v27, v27, v162, v51
    v_cvt_pk_bf16_f32 v66, v24, v25
    v_cvt_pk_bf16_f32 v67, v26, v27
    buffer_store_dwordx2 v[66:67], v10, s[24:27], 0 offen offset:96
    v_sub_f32 v28, v28, v52
    v_fma_f32 v28, v28, v162, v52
    v_sub_f32 v29, v29, v53
    v_fma_f32 v29, v29, v162, v53
    v_sub_f32 v30, v30, v54
    v_fma_f32 v30, v30, v162, v54
    v_sub_f32 v31, v31, v55
    v_fma_f32 v31, v31, v162, v55
    v_cvt_pk_bf16_f32 v68, v28, v29
    v_cvt_pk_bf16_f32 v69, v30, v31
    buffer_store_dwordx2 v[68:69], v10, s[24:27], 0 offen offset:128
L_k3_exit:
    s_endpgm
.section .rodata,"a"
.p2align 6
.amdhsa_kernel qkv_dft1_kernel
  .amdhsa_next_free_vgpr 176
  .amdhsa_next_free_sgpr 102
  .amdhsa_accum_offset 176
  .amdhsa_group_segment_fixed_size 0
  .amdhsa_kernarg_size 96
  .amdhsa_user_sgpr_count 2
  .amdhsa_user_sgpr_kernarg_segment_ptr 1
  .amdhsa_system_sgpr_workgroup_id_x 1
.end_amdhsa_kernel
.p2align 6
.amdhsa_kernel attn_dft2_kernel
  .amdhsa_next_free_vgpr 168
  .amdhsa_next_free_sgpr 102
  .amdhsa_accum_offset 168
  .amdhsa_group_segment_fixed_size 0
  .amdhsa_kernarg_size 96
  .amdhsa_user_sgpr_count 2
  .amdhsa_user_sgpr_kernarg_segment_ptr 1
  .amdhsa_system_sgpr_workgroup_id_x 1
.end_amdhsa_kernel
.p2align 6
.amdhsa_kernel outproj_mix_kernel
  .amdhsa_next_free_vgpr 188
  .amdhsa_next_free_sgpr 102
  .amdhsa_accum_offset 188
  .amdhsa_group_segment_fixed_size 0
  .amdhsa_kernarg_size 96
  .amdhsa_user_sgpr_count 2
  .amdhsa_user_sgpr_kernarg_segment_ptr 1
  .amdhsa_system_sgpr_workgroup_id_x 1
.end_amdhsa_kernel
```
